```python
import torch

def _softmax(x, axis=-1):
    return torch.softmax(x, dim=axis)
def _gelu(x):
    return torch.nn.functional.gelu(x, approximate="tanh")
def _silu(x):
    return torch.nn.functional.silu(x)
def _sigmoid(x):
    return torch.sigmoid(x)
def _layernorm(x, axis=-1, eps=1e-5):
    m = x.mean(dim=axis, keepdim=True)
    v = x.var(dim=axis, keepdim=True, unbiased=False)
    return (x - m) / torch.sqrt(v + eps)
def _scatter_add(tgt, idx, src, axis=0):
    return tgt.clone().index_add_(axis, idx, src)
def _segment_sum(src, seg, n):
    out = torch.zeros((n,) + src.shape[1:], dtype=src.dtype)
    return out.index_add_(0, seg, src)
def _pad(x, pw):
    flat = tuple(v for pair in reversed(pw) for v in pair)
    return torch.nn.functional.pad(x, flat)

kernel_name = 'gated_mix__linear_attn_block__ssm_conv_s4d__prompt'

def setup_inputs():

    _w = (lambda a: (lambda t: t.to(torch.bfloat16) if t.is_floating_point() else t)(torch.as_tensor(a)))
    def _A_setup():
        B, S, D = 1, 2048, 512
        return {
            "x": _w((lambda *s: torch.randn(*s, dtype=torch.bfloat16) * 0.05)(B, S, D)),
            "wqkv": _w((lambda *s: torch.randn(*s, dtype=torch.bfloat16) * 0.8)(D, 3 * D)),
            "wo": _w((lambda *s: torch.randn(*s, dtype=torch.bfloat16) * 0.05)(D, D)),
        }
    _A_in = _A_setup()

    def _B_setup():
        Bsz, L, D, N = 1, 2048, 512, 128
        return {
            "u": _w((lambda *s: torch.randn(*s, dtype=torch.bfloat16) * 0.05)(Bsz, L, D)),
            "log_A_real": _w((lambda *s: torch.randn(*s, dtype=torch.bfloat16) * 6.4)(D, N) * 0.5),
            "A_imag": _w((lambda *s: torch.randn(*s, dtype=torch.bfloat16) * 0.05)(D, N) * 3.14),
            "C_real": _w((lambda *s: torch.randn(*s, dtype=torch.bfloat16) * 0.2)(D, N) / N ** 0.5),
            "C_imag": _w((lambda *s: torch.randn(*s, dtype=torch.bfloat16) * 0.2)(D, N) / N ** 0.5),
            "log_dt": _w((lambda *s: torch.randn(*s, dtype=torch.bfloat16) * 0.05)(D) * 0.5 - 4.0),
            "D_skip": _w((lambda *s: torch.randn(*s, dtype=torch.bfloat16) * 0.05)(D)),
        }
    _B_in = _B_setup()

    return {
        "A_x": _A_in["x"],
        "A_wqkv": _A_in["wqkv"],
        "A_wo": _A_in["wo"],
        "B_u": _B_in["u"],
        "B_log_A_real": _B_in["log_A_real"],
        "B_A_imag": _B_in["A_imag"],
        "B_C_real": _B_in["C_real"],
        "B_C_imag": _B_in["C_imag"],
        "B_log_dt": _B_in["log_dt"],
        "B_D_skip": _B_in["D_skip"],
        "gate_w": _w((lambda *s: torch.randn(*s, dtype=torch.bfloat16) * 0.05)(512) * 16.0),
    }

def reference(A_x, A_wqkv, A_wo, B_u, B_log_A_real, B_A_imag, B_C_real, B_C_imag, B_log_dt, B_D_skip, gate_w):
    def _A_ref(x, wqkv, wo):
        B, S, D = x.shape
        H = 32; Dh = D // H
        qkv = (lambda x, *d: x.permute(*d))((x @ wqkv).reshape(B, S, 3, H, Dh), 2, 0, 3, 1, 4)
        q, k, v = qkv[0], qkv[1], qkv[2]
        phi = lambda t: torch.where(t > 0, t + 1, torch.exp(t)) + 1e-6
        pq, pk = phi(q), phi(k)
        kv = torch.einsum("bhsd,bhse->bhde", pk, v)
        z = torch.einsum("bhsd->bhd", pk)
        num = torch.einsum("bhqd,bhde->bhqe", pq, kv)
        den = torch.einsum("bhqd,bhd->bhq", pq, z)[..., None] + 1e-6
        o = num / den
        return (lambda x, *d: x.permute(*d))(o, 0, 2, 1, 3).reshape(B, S, D) @ wo

    def _B_ref(u, log_A_real, A_imag, C_real, C_imag, log_dt, D_skip):
        L = u.shape[1]
        dt = torch.exp(log_dt)
        A = -torch.exp(log_A_real) + 1j * A_imag
        C = (C_real + 1j * C_imag) * dt[:, None]
        pos = (lambda x, dt: x.to(dt))(torch.arange(L), log_dt.dtype)
        P = torch.exp((A * dt[:, None])[:, :, None] * pos[None, None, :])
        K = 2.0 * torch.einsum("dn,dnl->dl", C, P).real
        L2 = 2 * L
        u_t = (lambda x, *d: x.permute(*d))(u, 0, 2, 1)
        Kf = (lambda x, *a, **k: torch.fft.rfft(x.float(), *a, **k))(K, L2)
        Uf = (lambda x, *a, **k: torch.fft.rfft(x.float(), *a, **k))(u_t, L2)
        y = (lambda x, *a, **k: torch.fft.irfft(x, *a, **k).to(torch.bfloat16))(Uf * Kf[None, :, :], L2)[:, :, :L]
        y = (lambda x, *d: x.permute(*d))(y, 0, 2, 1)
        return y + u * D_skip[None, None, :]

    x = A_x
    g = _sigmoid((x * gate_w).sum(-1, keepdims=True))
    a = _A_ref(x, A_wqkv, A_wo)
    b = _B_ref(x, B_log_A_real, B_A_imag, B_C_real, B_C_imag, B_log_dt, B_D_skip)
    return g * a + (1 - g) * b
```

```asm
; @launch kernel=k1_kernel grid=(256,1,1) block=(512,1,1) lds=163840
; @launch kernel=k2_kernel grid=(256,1,1) block=(256,1,1) lds=123904
.amdgcn_target "amdgcn-amd-amdhsa--gfx950"
.text
.globl k1_kernel
.p2align 10
.type k1_kernel,@function
k1_kernel:
    s_cmp_ge_u32 s2, 256
    s_cbranch_scc1 K1_exit
    s_load_dwordx16 s[16:31], s[0:1], 0
    s_load_dwordx8 s[32:39], s[0:1], 64
    s_load_dwordx4 s[40:43], s[0:1], 96
    s_getpc_b64 s[12:13]
K1_pc:
    s_bfe_u32 s14, s2, 0x20003
    s_lshl_b32 s14, s14, 13
    v_lshl_add_u32 v2, v0, 4, s14
    s_sub_u32 s12, s12, K1_pc-k1_kernel
    s_subb_u32 s13, s13, 0
    v_min_u32 v2, CODE_END-k1_kernel-16, v2
    global_load_dwordx4 v[252:255], v2, s[12:13]
    v_lshrrev_b32 v1, 6, v0
    s_and_b32 s3, s2, 7
    s_lshr_b32 s4, s2, 3
    v_readfirstlane_b32 s5, v1
    s_cmp_ge_u32 s4, 16
    s_nop 3
    s_cbranch_scc1 K1_A
    s_and_b32 s44, s5, 3
    s_lshr_b32 s45, s5, 2
    s_lshl_b32 s46, s3, 6
    s_lshl_b32 s48, s4, 2
    s_add_u32 s46, s46, s48
    s_add_u32 s47, s46, s44
    v_and_b32 v1, 63, v0
    s_lshl_b32 s48, s47, 8
    s_lshl_b32 s51, s45, 7
    s_add_u32 s48, s48, s51
    v_lshl_add_u32 v22, v1, 1, s48
    s_lshl_b32 s48, s47, 1
    v_mov_b32 v23, s48
    s_lshl_b32 s51, s4, 5
    v_add_u32 v24, s51, v0
    v_and_b32 v24, 0x1ff, v24
    s_waitcnt lgkmcnt(0)
    global_load_ushort v20, v23, s[32:33]
    global_load_ushort v16, v22, s[24:25]
    global_load_ushort v17, v22, s[26:27]
    global_load_ushort v18, v22, s[28:29]
    global_load_ushort v19, v22, s[30:31]
    global_load_ushort v21, v23, s[34:35]
    s_lshl_b32 s48, s46, 1
    v_add_u32 v25, s4, v0
    v_and_b32 v25, 3, v25
    v_lshl_add_u32 v26, v24, 2, v25
    v_lshl_add_u32 v150, v26, 10, s48
    v_xor_b32 v151, 1024, v150
    v_xor_b32 v152, 2048, v150
    v_xor_b32 v153, 3072, v150
    s_barrier
    global_load_dwordx2 v[140:141], v150, s[16:17]
    s_branch B_rest
K1_A:
    s_sub_u32 s47, s4, 16
    s_lshr_b32 s44, s47, 2
    s_and_b32 s45, s47, 3
    s_add_u32 s46, s44, s45
    s_and_b32 s46, s46, 3
    s_lshl_b32 s46, s46, 1
    s_lshr_b32 s47, s3, 1
    s_lshl_b32 s47, s47, 2
    s_add_u32 s44, s44, s47
    s_and_b32 s47, s3, 1
    s_lshl_b32 s47, s47, 2
    s_add_u32 s45, s45, s47
    v_and_b32 v1, 63, v0
    s_and_b32 s49, s5, 3
    v_lshrrev_b32 v10, 3, v1
    v_and_b32 v11, 7, v1
    v_lshrrev_b32 v12, 4, v1
    v_xor_b32 v13, v11, v12
    v_lshlrev_b32 v13, 4, v13
    v_lshl_add_u32 v2, v10, 10, v13
    v_xor_b32 v3, 64, v2
    v_and_b32 v12, 1, v12
    v_lshlrev_b32 v12, 2, v12
    v_xor_b32 v13, v11, v12
    v_lshlrev_b32 v13, 4, v13
    v_mul_u32_u24 v9, 3072, v10
    v_add_u32 v9, v9, v13
    s_lshl_b32 s8, s44, 17
    s_lshl_b32 s47, s49, 15
    s_add_u32 s8, s8, s47
    s_mul_i32 s9, s49, 49152
    s_lshl_b32 s47, s45, 7
    s_add_u32 s9, s9, s47
    s_lshl_b32 s15, s49, 12
    s_lshl_b32 s7, s49, 11
    s_mov_b32 s54, 0x200000
    s_mov_b32 s55, 0x00020000
    s_mov_b32 s58, 0x180000
    s_mov_b32 s59, 0x00020000
    s_cmp_lt_u32 s5, 4
    s_cbranch_scc1 A_setA
    s_waitcnt lgkmcnt(0)
    s_mov_b32 s52, s16
    s_mov_b32 s53, s17
    s_mov_b32 s56, s18
    s_mov_b32 s57, s19
    s_add_u32 s12, s46, 0
    s_and_b32 s12, s12, 7
    s_mul_i32 s11, s12, 196608
    s_add_u32 s11, s11, s9
    s_add_u32 m0, s7, 114688
    s_add_u32 s10, s11, 1024
    buffer_load_dwordx4 v9, s[56:59], s10 offen lds
    s_add_u32 m0, s7, 115712
    s_add_u32 s10, s11, 25600
    buffer_load_dwordx4 v9, s[56:59], s10 offen lds
    s_add_u32 m0, s7, 122880
    s_add_u32 s10, s11, 2048
    buffer_load_dwordx4 v9, s[56:59], s10 offen lds
    s_add_u32 m0, s7, 123904
    s_add_u32 s10, s11, 26624
    buffer_load_dwordx4 v9, s[56:59], s10 offen lds
    s_lshl_b32 s10, s12, 7
    s_add_u32 m0, s15, 0
    s_add_u32 s10, s10, s8
    buffer_load_dwordx4 v2, s[52:55], s10 offen lds
    s_add_u32 m0, m0, 1024
    s_add_u32 s10, s10, 8192
    buffer_load_dwordx4 v3, s[52:55], s10 offen lds
    s_add_u32 m0, m0, 1024
    s_add_u32 s10, s10, 8192
    buffer_load_dwordx4 v2, s[52:55], s10 offen lds
    s_add_u32 m0, m0, 1024
    s_add_u32 s10, s10, 8192
    buffer_load_dwordx4 v3, s[52:55], s10 offen lds
    s_lshr_b32 s50, s49, 1
    s_and_b32 s51, s49, 1
    v_and_b32 v10, 31, v1
    v_lshrrev_b32 v11, 5, v1
    v_bfe_u32 v12, v10, 1, 3
    v_xor_b32 v12, v12, v11
    s_lshl_b32 s47, s50, 13
    v_lshl_add_u32 v13, v10, 7, s47
    v_xor_b32 v14, 0, v12
    v_lshl_add_u32 v16, v14, 4, v13
    v_add_u32 v20, 0x10000, v16
    v_add_u32 v24, 0x20000, v16
    v_xor_b32 v14, 2, v12
    v_lshl_add_u32 v17, v14, 4, v13
    v_add_u32 v21, 0x10000, v17
    v_add_u32 v25, 0x20000, v17
    v_xor_b32 v14, 4, v12
    v_lshl_add_u32 v18, v14, 4, v13
    v_add_u32 v22, 0x10000, v18
    v_add_u32 v26, 0x20000, v18
    v_xor_b32 v14, 6, v12
    v_lshl_add_u32 v19, v14, 4, v13
    v_add_u32 v23, 0x10000, v19
    v_add_u32 v27, 0x20000, v19
    v_bfe_u32 v10, v1, 2, 2
    v_lshl_add_u32 v12, v11, 3, v10
    v_lshlrev_b32 v12, 7, v12
    v_bfe_u32 v13, v1, 4, 1
    v_bfe_u32 v14, v1, 1, 1
    v_lshl_add_u32 v13, v13, 1, v14
    v_bfe_u32 v14, v1, 3, 1
    v_xor_b32 v14, s51, v14
    v_lshl_add_u32 v13, v14, 2, v13
    v_lshl_add_u32 v12, v13, 4, v12
    v_and_b32 v14, 1, v1
    v_lshl_add_u32 v28, v14, 3, v12
    v_add_u32 v29, 114688, v28
    s_mov_b32 s64, 0x3fb8aa3b
    s_mov_b32 s65, 0x3fb8aa3b
    s_mov_b32 s66, 0x358637bd
    v_and_b32 v10, 15, v1
    s_lshl_b32 s47, s45, 4
    v_add_u32 v10, s47, v10
    v_lshrrev_b32 v11, 4, v1
    v_bfe_u32 v12, v10, 1, 3
    v_xor_b32 v12, v12, v11
    v_lshlrev_b32 v12, 4, v12
    v_lshl_add_u32 v30, v10, 7, v12
    s_lshl_b32 s47, s51, 6
    v_xor_b32 v30, s47, v30
    v_add_u32 v31, 0x10000, v30
    v_add_u32 v32, 0x20000, v30
    v_lshlrev_b32 v33, 4, v11
    v_add_u32 v13, s47, v33
    v_mov_b32 v64, s66
    v_mov_b32 v65, s66
    v_mov_b32 v66, s66
    v_mov_b32 v67, s66
    v_mov_b32 v68, s66
    v_mov_b32 v69, s66
    v_mov_b32 v70, s66
    v_mov_b32 v71, s66
    v_mov_b32 v72, s66
    v_mov_b32 v73, s66
    v_mov_b32 v74, s66
    v_mov_b32 v75, s66
    v_mov_b32 v76, s66
    v_mov_b32 v77, s66
    v_mov_b32 v78, s66
    v_mov_b32 v79, s66
    v_mov_b32 v80, s66
    v_mov_b32 v81, s66
    v_mov_b32 v82, s66
    v_mov_b32 v83, s66
    v_mov_b32 v84, s66
    v_mov_b32 v85, s66
    v_mov_b32 v86, s66
    v_mov_b32 v87, s66
    v_mov_b32 v88, s66
    v_mov_b32 v89, s66
    v_mov_b32 v90, s66
    v_mov_b32 v91, s66
    v_mov_b32 v92, s66
    v_mov_b32 v93, s66
    v_mov_b32 v94, s66
    v_mov_b32 v95, s66
    s_add_u32 s12, s46, 2
    s_and_b32 s12, s12, 7
    s_mul_i32 s11, s12, 196608
    s_add_u32 s11, s11, s9
    s_add_u32 m0, s7, 131072
    s_add_u32 s10, s11, 1024
    buffer_load_dwordx4 v9, s[56:59], s10 offen lds
    s_add_u32 m0, s7, 132096
    s_add_u32 s10, s11, 25600
    buffer_load_dwordx4 v9, s[56:59], s10 offen lds
    s_add_u32 m0, s7, 139264
    s_add_u32 s10, s11, 2048
    buffer_load_dwordx4 v9, s[56:59], s10 offen lds
    s_add_u32 m0, s7, 140288
    s_add_u32 s10, s11, 26624
    buffer_load_dwordx4 v9, s[56:59], s10 offen lds
    s_lshl_b32 s10, s12, 7
    s_add_u32 m0, s15, 16384
    s_add_u32 s10, s10, s8
    buffer_load_dwordx4 v2, s[52:55], s10 offen lds
    s_add_u32 m0, m0, 1024
    s_add_u32 s10, s10, 8192
    buffer_load_dwordx4 v3, s[52:55], s10 offen lds
    s_add_u32 m0, m0, 1024
    s_add_u32 s10, s10, 8192
    buffer_load_dwordx4 v2, s[52:55], s10 offen lds
    s_add_u32 m0, m0, 1024
    s_add_u32 s10, s10, 8192
    buffer_load_dwordx4 v3, s[52:55], s10 offen lds
    s_waitcnt vmcnt(8)
    s_barrier
    s_add_u32 s12, s46, 4
    s_and_b32 s12, s12, 7
    s_mul_i32 s11, s12, 196608
    s_add_u32 s11, s11, s9
    s_add_u32 m0, s7, 147456
    s_add_u32 s10, s11, 1024
    buffer_load_dwordx4 v9, s[56:59], s10 offen lds
    s_add_u32 m0, s7, 148480
    s_add_u32 s10, s11, 25600
    buffer_load_dwordx4 v9, s[56:59], s10 offen lds
    s_add_u32 m0, s7, 155648
    s_add_u32 s10, s11, 2048
    buffer_load_dwordx4 v9, s[56:59], s10 offen lds
    s_add_u32 m0, s7, 156672
    s_add_u32 s10, s11, 26624
    buffer_load_dwordx4 v9, s[56:59], s10 offen lds
    s_lshl_b32 s10, s12, 7
    s_add_u32 m0, s15, 32768
    s_add_u32 s10, s10, s8
    buffer_load_dwordx4 v2, s[52:55], s10 offen lds
    s_add_u32 m0, m0, 1024
    s_add_u32 s10, s10, 8192
    buffer_load_dwordx4 v3, s[52:55], s10 offen lds
    s_add_u32 m0, m0, 1024
    s_add_u32 s10, s10, 8192
    buffer_load_dwordx4 v2, s[52:55], s10 offen lds
    s_add_u32 m0, m0, 1024
    s_add_u32 s10, s10, 8192
    buffer_load_dwordx4 v3, s[52:55], s10 offen lds
    s_waitcnt vmcnt(8)
    s_barrier
    s_add_u32 s12, s46, 6
    s_and_b32 s12, s12, 7
    s_mul_i32 s11, s12, 196608
    s_add_u32 s11, s11, s9
    s_add_u32 m0, s7, 114688
    s_add_u32 s10, s11, 1024
    buffer_load_dwordx4 v9, s[56:59], s10 offen lds
    s_add_u32 m0, s7, 115712
    s_add_u32 s10, s11, 25600
    buffer_load_dwordx4 v9, s[56:59], s10 offen lds
    s_add_u32 m0, s7, 122880
    s_add_u32 s10, s11, 2048
    buffer_load_dwordx4 v9, s[56:59], s10 offen lds
    s_add_u32 m0, s7, 123904
    s_add_u32 s10, s11, 26624
    buffer_load_dwordx4 v9, s[56:59], s10 offen lds
    s_lshl_b32 s10, s12, 7
    s_add_u32 m0, s15, 49152
    s_add_u32 s10, s10, s8
    buffer_load_dwordx4 v2, s[52:55], s10 offen lds
    s_add_u32 m0, m0, 1024
    s_add_u32 s10, s10, 8192
    buffer_load_dwordx4 v3, s[52:55], s10 offen lds
    s_add_u32 m0, m0, 1024
    s_add_u32 s10, s10, 8192
    buffer_load_dwordx4 v2, s[52:55], s10 offen lds
    s_add_u32 m0, m0, 1024
    s_add_u32 s10, s10, 8192
    buffer_load_dwordx4 v3, s[52:55], s10 offen lds
    s_waitcnt vmcnt(8)
    s_barrier
    s_add_u32 s12, s46, 1
    s_and_b32 s12, s12, 7
    s_mul_i32 s11, s12, 196608
    s_add_u32 s11, s11, s9
    s_add_u32 m0, s7, 131072
    s_add_u32 s10, s11, 1024
    buffer_load_dwordx4 v9, s[56:59], s10 offen lds
    s_add_u32 m0, s7, 132096
    s_add_u32 s10, s11, 25600
    buffer_load_dwordx4 v9, s[56:59], s10 offen lds
    s_add_u32 m0, s7, 139264
    s_add_u32 s10, s11, 2048
    buffer_load_dwordx4 v9, s[56:59], s10 offen lds
    s_add_u32 m0, s7, 140288
    s_add_u32 s10, s11, 26624
    buffer_load_dwordx4 v9, s[56:59], s10 offen lds
    s_lshl_b32 s10, s12, 7
    s_add_u32 m0, s15, 65536
    s_add_u32 s10, s10, s8
    buffer_load_dwordx4 v2, s[52:55], s10 offen lds
    s_add_u32 m0, m0, 1024
    s_add_u32 s10, s10, 8192
    buffer_load_dwordx4 v3, s[52:55], s10 offen lds
    s_add_u32 m0, m0, 1024
    s_add_u32 s10, s10, 8192
    buffer_load_dwordx4 v2, s[52:55], s10 offen lds
    s_add_u32 m0, m0, 1024
    s_add_u32 s10, s10, 8192
    buffer_load_dwordx4 v3, s[52:55], s10 offen lds
    s_waitcnt vmcnt(8)
    s_barrier
    s_add_u32 s12, s46, 3
    s_and_b32 s12, s12, 7
    s_mul_i32 s11, s12, 196608
    s_add_u32 s11, s11, s9
    s_add_u32 m0, s7, 147456
    s_add_u32 s10, s11, 1024
    buffer_load_dwordx4 v9, s[56:59], s10 offen lds
    s_add_u32 m0, s7, 148480
    s_add_u32 s10, s11, 25600
    buffer_load_dwordx4 v9, s[56:59], s10 offen lds
    s_add_u32 m0, s7, 155648
    s_add_u32 s10, s11, 2048
    buffer_load_dwordx4 v9, s[56:59], s10 offen lds
    s_add_u32 m0, s7, 156672
    s_add_u32 s10, s11, 26624
    buffer_load_dwordx4 v9, s[56:59], s10 offen lds
    s_lshl_b32 s10, s12, 7
    s_add_u32 m0, s15, 81920
    s_add_u32 s10, s10, s8
    buffer_load_dwordx4 v2, s[52:55], s10 offen lds
    s_add_u32 m0, m0, 1024
    s_add_u32 s10, s10, 8192
    buffer_load_dwordx4 v3, s[52:55], s10 offen lds
    s_add_u32 m0, m0, 1024
    s_add_u32 s10, s10, 8192
    buffer_load_dwordx4 v2, s[52:55], s10 offen lds
    s_add_u32 m0, m0, 1024
    s_add_u32 s10, s10, 8192
    buffer_load_dwordx4 v3, s[52:55], s10 offen lds
    s_waitcnt vmcnt(8)
    s_barrier
    s_add_u32 s12, s46, 5
    s_and_b32 s12, s12, 7
    s_mul_i32 s11, s12, 196608
    s_add_u32 s11, s11, s9
    s_add_u32 m0, s7, 114688
    s_add_u32 s10, s11, 1024
    buffer_load_dwordx4 v9, s[56:59], s10 offen lds
    s_add_u32 m0, s7, 115712
    s_add_u32 s10, s11, 25600
    buffer_load_dwordx4 v9, s[56:59], s10 offen lds
    s_add_u32 m0, s7, 122880
    s_add_u32 s10, s11, 2048
    buffer_load_dwordx4 v9, s[56:59], s10 offen lds
    s_add_u32 m0, s7, 123904
    s_add_u32 s10, s11, 26624
    buffer_load_dwordx4 v9, s[56:59], s10 offen lds
    s_lshl_b32 s10, s12, 7
    s_add_u32 m0, s15, 98304
    s_add_u32 s10, s10, s8
    buffer_load_dwordx4 v2, s[52:55], s10 offen lds
    s_add_u32 m0, m0, 1024
    s_add_u32 s10, s10, 8192
    buffer_load_dwordx4 v3, s[52:55], s10 offen lds
    s_add_u32 m0, m0, 1024
    s_add_u32 s10, s10, 8192
    buffer_load_dwordx4 v2, s[52:55], s10 offen lds
    s_add_u32 m0, m0, 1024
    s_add_u32 s10, s10, 8192
    buffer_load_dwordx4 v3, s[52:55], s10 offen lds
    s_waitcnt vmcnt(8)
    s_barrier
    s_add_u32 s12, s46, 7
    s_and_b32 s12, s12, 7
    s_lshl_b32 s10, s12, 7
    s_add_u32 m0, s15, 131072
    s_add_u32 s10, s10, s8
    buffer_load_dwordx4 v2, s[52:55], s10 offen lds
    s_add_u32 m0, m0, 1024
    s_add_u32 s10, s10, 8192
    buffer_load_dwordx4 v3, s[52:55], s10 offen lds
    s_add_u32 m0, m0, 1024
    s_add_u32 s10, s10, 8192
    buffer_load_dwordx4 v2, s[52:55], s10 offen lds
    s_add_u32 m0, m0, 1024
    s_add_u32 s10, s10, 8192
    buffer_load_dwordx4 v3, s[52:55], s10 offen lds
    s_add_u32 s12, s46, 0
    s_and_b32 s12, s12, 7
    s_lshl_b32 s10, s12, 7
    v_add_u32 v10, s10, v13
    global_load_dwordx4 v[128:131], v10, s[36:37]
    s_add_u32 s12, s46, 2
    s_and_b32 s12, s12, 7
    s_lshl_b32 s10, s12, 7
    v_add_u32 v10, s10, v13
    global_load_dwordx4 v[132:135], v10, s[36:37]
    s_add_u32 s12, s46, 4
    s_and_b32 s12, s12, 7
    s_lshl_b32 s10, s12, 7
    v_add_u32 v10, s10, v13
    global_load_dwordx4 v[136:139], v10, s[36:37]
    s_add_u32 s12, s46, 6
    s_and_b32 s12, s12, 7
    s_lshl_b32 s10, s12, 7
    v_add_u32 v10, s10, v13
    global_load_dwordx4 v[140:143], v10, s[36:37]
    s_waitcnt vmcnt(8)
    s_barrier
    s_add_u32 s12, s46, 7
    s_and_b32 s12, s12, 7
    s_mul_i32 s11, s12, 196608
    s_add_u32 s11, s11, s9
    s_add_u32 m0, s7, 147456
    s_add_u32 s10, s11, 1024
    buffer_load_dwordx4 v9, s[56:59], s10 offen lds
    s_add_u32 m0, s7, 148480
    s_add_u32 s10, s11, 25600
    buffer_load_dwordx4 v9, s[56:59], s10 offen lds
    s_add_u32 m0, s7, 155648
    s_add_u32 s10, s11, 2048
    buffer_load_dwordx4 v9, s[56:59], s10 offen lds
    s_add_u32 m0, s7, 156672
    s_add_u32 s10, s11, 26624
    buffer_load_dwordx4 v9, s[56:59], s10 offen lds
    s_add_u32 s12, s46, 1
    s_and_b32 s12, s12, 7
    s_lshl_b32 s10, s12, 7
    v_add_u32 v10, s10, v13
    global_load_dwordx4 v[144:147], v10, s[36:37]
    s_add_u32 s12, s46, 3
    s_and_b32 s12, s12, 7
    s_lshl_b32 s10, s12, 7
    v_add_u32 v10, s10, v13
    global_load_dwordx4 v[148:151], v10, s[36:37]
    s_add_u32 s12, s46, 5
    s_and_b32 s12, s12, 7
    s_lshl_b32 s10, s12, 7
    v_add_u32 v10, s10, v13
    global_load_dwordx4 v[152:155], v10, s[36:37]
    s_add_u32 s12, s46, 7
    s_and_b32 s12, s12, 7
    s_lshl_b32 s10, s12, 7
    v_add_u32 v10, s10, v13
    global_load_dwordx4 v[156:159], v10, s[36:37]
    ds_read_b128 v[216:219], v30 offset:0
    ds_read_b128 v[220:223], v30 offset:16384
    ds_read_b128 v[224:227], v30 offset:32768
    ds_read_b128 v[228:231], v30 offset:49152
    s_waitcnt vmcnt(8) lgkmcnt(0)
    v_mfma_f32_16x16x32_bf16 v[164:167], v[216:219], v[128:131], 0
    v_mfma_f32_16x16x32_bf16 v[164:167], v[220:223], v[132:135], v[164:167]
    v_mfma_f32_16x16x32_bf16 v[164:167], v[224:227], v[136:139], v[164:167]
    v_mfma_f32_16x16x32_bf16 v[164:167], v[228:231], v[140:143], v[164:167]
    s_waitcnt vmcnt(4)
    s_barrier
    s_add_u32 s12, s46, 0
    s_and_b32 s12, s12, 7
    s_mul_i32 s11, s12, 196608
    s_add_u32 s11, s11, s9
    s_add_u32 m0, s7, 114688
    s_add_u32 s10, s11, 0
    buffer_load_dwordx4 v9, s[56:59], s10 offen lds
    s_add_u32 m0, s7, 115712
    s_add_u32 s10, s11, 24576
    buffer_load_dwordx4 v9, s[56:59], s10 offen lds
    s_add_u32 s12, s46, 1
    s_and_b32 s12, s12, 7
    s_mul_i32 s11, s12, 196608
    s_add_u32 s11, s11, s9
    s_add_u32 m0, s7, 122880
    s_add_u32 s10, s11, 0
    buffer_load_dwordx4 v9, s[56:59], s10 offen lds
    s_add_u32 m0, s7, 123904
    s_add_u32 s10, s11, 24576
    buffer_load_dwordx4 v9, s[56:59], s10 offen lds
    ds_read_b128 v[216:219], v31 offset:0
    ds_read_b128 v[220:223], v31 offset:16384
    ds_read_b128 v[224:227], v31 offset:32768
    s_waitcnt vmcnt(4) lgkmcnt(0)
    v_mfma_f32_16x16x32_bf16 v[164:167], v[216:219], v[144:147], v[164:167]
    v_mfma_f32_16x16x32_bf16 v[164:167], v[220:223], v[148:151], v[164:167]
    v_mfma_f32_16x16x32_bf16 v[164:167], v[224:227], v[152:155], v[164:167]
    ds_read_b128 v[160:163], v32 offset:0
    s_lshl_b32 s47, s44, 2
    s_lshl_b32 s48, s50, 1
    s_add_u32 s47, s47, s48
    s_lshl_b32 s47, s47, 5
    s_lshl_b32 s48, s45, 2
    s_add_u32 s47, s47, s48
    s_lshl_b32 s48, s51, 1
    s_add_u32 s47, s47, s48
    s_lshl_b32 s47, s47, 10
    s_add_u32 s70, s42, s47
    s_addc_u32 s71, s43, 0
    v_lshlrev_b32 v2, 4, v1
    v_add_u32 v3, 0x8000, v2
    s_waitcnt lgkmcnt(0)
    v_mfma_f32_16x16x32_bf16 v[164:167], v[160:163], v[156:159], v[164:167]
    ds_read_b128 v[168:171], v16 offset:0
    ds_read_b128 v[172:175], v16 offset:4096
    ds_read_b128 v[180:183], v17 offset:0
    ds_read_b128 v[184:187], v17 offset:4096
    ds_read_b128 v[192:195], v18 offset:0
    ds_read_b128 v[196:199], v18 offset:4096
    s_barrier
    s_waitcnt vmcnt(0)
    s_barrier
    ds_read_b64_tr_b16 v[176:177], v29 offset:0
    ds_read_b64_tr_b16 v[178:179], v29 offset:512
    ds_read_b64_tr_b16 v[188:189], v29 offset:2048
    ds_read_b64_tr_b16 v[190:191], v29 offset:2560
    ds_read_b64_tr_b16 v[200:201], v29 offset:4096
    ds_read_b64_tr_b16 v[202:203], v29 offset:4608
    s_waitcnt lgkmcnt(4)
    v_mfma_f32_32x32x16_bf16 v[64:79], v[176:179], v[168:171], v[64:79]
    ds_read_b128 v[204:207], v19 offset:0
    ds_read_b64_tr_b16 v[212:213], v29 offset:6144
    v_mfma_f32_32x32x16_bf16 v[80:95], v[176:179], v[172:175], v[80:95]
    ds_read_b128 v[208:211], v19 offset:4096
    ds_read_b64_tr_b16 v[214:215], v29 offset:6656
    s_waitcnt lgkmcnt(6)
    v_mfma_f32_32x32x16_bf16 v[64:79], v[188:191], v[180:183], v[64:79]
    ds_read_b128 v[168:171], v20 offset:0
    ds_read_b64_tr_b16 v[176:177], v29 offset:8192
    v_mfma_f32_32x32x16_bf16 v[80:95], v[188:191], v[184:187], v[80:95]
    ds_read_b128 v[172:175], v20 offset:4096
    ds_read_b64_tr_b16 v[178:179], v29 offset:8704
    s_waitcnt lgkmcnt(8)
    v_mfma_f32_32x32x16_bf16 v[64:79], v[200:203], v[192:195], v[64:79]
    s_waitcnt lgkmcnt(4)
    s_barrier
    ds_read_b128 v[180:183], v21 offset:0
    ds_read_b64_tr_b16 v[188:189], v29 offset:10240
    v_mfma_f32_32x32x16_bf16 v[80:95], v[200:203], v[196:199], v[80:95]
    ds_read_b128 v[184:187], v21 offset:4096
    ds_read_b64_tr_b16 v[190:191], v29 offset:10752
    v_mfma_f32_32x32x16_bf16 v[64:79], v[212:215], v[204:207], v[64:79]
    ds_read_b128 v[192:195], v22 offset:0
    ds_read_b64_tr_b16 v[200:201], v29 offset:12288
    v_mfma_f32_32x32x16_bf16 v[80:95], v[212:215], v[208:211], v[80:95]
    ds_read_b128 v[196:199], v22 offset:4096
    ds_read_b64_tr_b16 v[202:203], v29 offset:12800
    s_waitcnt lgkmcnt(8)
    v_mfma_f32_32x32x16_bf16 v[64:79], v[176:179], v[168:171], v[64:79]
    ds_read_b128 v[204:207], v23 offset:0
    ds_read_b64_tr_b16 v[212:213], v29 offset:14336
    v_mfma_f32_32x32x16_bf16 v[80:95], v[176:179], v[172:175], v[80:95]
    ds_read_b128 v[208:211], v23 offset:4096
    ds_read_b64_tr_b16 v[214:215], v29 offset:14848
    s_waitcnt lgkmcnt(8)
    v_mfma_f32_32x32x16_bf16 v[64:79], v[188:191], v[180:183], v[64:79]
    ds_read_b128 v[168:171], v16 offset:16384
    ds_read_b64_tr_b16 v[176:177], v29 offset:32768
    v_mfma_f32_32x32x16_bf16 v[80:95], v[188:191], v[184:187], v[80:95]
    ds_read_b128 v[172:175], v16 offset:20480
    ds_read_b64_tr_b16 v[178:179], v29 offset:33280
    s_waitcnt lgkmcnt(8)
    v_mfma_f32_32x32x16_bf16 v[64:79], v[200:203], v[192:195], v[64:79]
    ds_read_b128 v[180:183], v17 offset:16384
    ds_read_b64_tr_b16 v[188:189], v29 offset:34816
    v_mfma_f32_32x32x16_bf16 v[80:95], v[200:203], v[196:199], v[80:95]
    ds_read_b128 v[184:187], v17 offset:20480
    ds_read_b64_tr_b16 v[190:191], v29 offset:35328
    s_waitcnt lgkmcnt(8)
    v_mfma_f32_32x32x16_bf16 v[64:79], v[212:215], v[204:207], v[64:79]
    ds_read_b128 v[192:195], v18 offset:16384
    ds_read_b64_tr_b16 v[200:201], v29 offset:36864
    v_mfma_f32_32x32x16_bf16 v[80:95], v[212:215], v[208:211], v[80:95]
    ds_read_b128 v[196:199], v18 offset:20480
    ds_read_b64_tr_b16 v[202:203], v29 offset:37376
    s_waitcnt lgkmcnt(8)
    v_mfma_f32_32x32x16_bf16 v[64:79], v[176:179], v[168:171], v[64:79]
    ds_read_b128 v[204:207], v19 offset:16384
    ds_read_b64_tr_b16 v[212:213], v29 offset:38912
    v_mfma_f32_32x32x16_bf16 v[80:95], v[176:179], v[172:175], v[80:95]
    ds_read_b128 v[208:211], v19 offset:20480
    ds_read_b64_tr_b16 v[214:215], v29 offset:39424
    s_waitcnt lgkmcnt(8)
    v_mfma_f32_32x32x16_bf16 v[64:79], v[188:191], v[180:183], v[64:79]
    ds_read_b128 v[168:171], v20 offset:16384
    ds_read_b64_tr_b16 v[176:177], v29 offset:40960
    v_mfma_f32_32x32x16_bf16 v[80:95], v[188:191], v[184:187], v[80:95]
    ds_read_b128 v[172:175], v20 offset:20480
    ds_read_b64_tr_b16 v[178:179], v29 offset:41472
    s_waitcnt lgkmcnt(8)
    v_mfma_f32_32x32x16_bf16 v[64:79], v[200:203], v[192:195], v[64:79]
    ds_read_b128 v[180:183], v21 offset:16384
    ds_read_b64_tr_b16 v[188:189], v29 offset:43008
    v_mfma_f32_32x32x16_bf16 v[80:95], v[200:203], v[196:199], v[80:95]
    ds_read_b128 v[184:187], v21 offset:20480
    ds_read_b64_tr_b16 v[190:191], v29 offset:43520
    s_waitcnt lgkmcnt(8)
    v_mfma_f32_32x32x16_bf16 v[64:79], v[212:215], v[204:207], v[64:79]
    ds_read_b128 v[192:195], v22 offset:16384
    ds_read_b64_tr_b16 v[200:201], v29 offset:45056
    v_mfma_f32_32x32x16_bf16 v[80:95], v[212:215], v[208:211], v[80:95]
    ds_read_b128 v[196:199], v22 offset:20480
    ds_read_b64_tr_b16 v[202:203], v29 offset:45568
    s_waitcnt lgkmcnt(8)
    v_mfma_f32_32x32x16_bf16 v[64:79], v[176:179], v[168:171], v[64:79]
    ds_read_b128 v[204:207], v23 offset:16384
    ds_read_b64_tr_b16 v[212:213], v29 offset:47104
    v_mfma_f32_32x32x16_bf16 v[80:95], v[176:179], v[172:175], v[80:95]
    ds_read_b128 v[208:211], v23 offset:20480
    ds_read_b64_tr_b16 v[214:215], v29 offset:47616
    s_waitcnt lgkmcnt(8)
    v_mfma_f32_32x32x16_bf16 v[64:79], v[188:191], v[180:183], v[64:79]
    s_barrier
    v_add_u32 v13, 65536, v13
    ds_write_b128 v13, v[164:167] offset:8704
    ds_read_b128 v[168:171], v16 offset:32768
    ds_read_b64_tr_b16 v[176:177], v29 offset:0
    v_mfma_f32_32x32x16_bf16 v[80:95], v[188:191], v[184:187], v[80:95]
    ds_read_b128 v[172:175], v16 offset:36864
    ds_read_b64_tr_b16 v[178:179], v29 offset:512
    s_waitcnt lgkmcnt(9)
    v_mfma_f32_32x32x16_bf16 v[64:79], v[200:203], v[192:195], v[64:79]
    ds_read_b128 v[180:183], v17 offset:32768
    ds_read_b64_tr_b16 v[188:189], v29 offset:2048
    v_mfma_f32_32x32x16_bf16 v[80:95], v[200:203], v[196:199], v[80:95]
    ds_read_b128 v[184:187], v17 offset:36864
    ds_read_b64_tr_b16 v[190:191], v29 offset:2560
    s_waitcnt lgkmcnt(9)
    v_mfma_f32_32x32x16_bf16 v[64:79], v[212:215], v[204:207], v[64:79]
    ds_read_b128 v[192:195], v18 offset:32768
    ds_read_b64_tr_b16 v[200:201], v29 offset:4096
    v_mfma_f32_32x32x16_bf16 v[80:95], v[212:215], v[208:211], v[80:95]
    ds_read_b128 v[196:199], v18 offset:36864
    ds_read_b64_tr_b16 v[202:203], v29 offset:4608
    s_waitcnt lgkmcnt(8)
    v_mfma_f32_32x32x16_bf16 v[64:79], v[176:179], v[168:171], v[64:79]
    ds_read_b128 v[204:207], v19 offset:32768
    ds_read_b64_tr_b16 v[212:213], v29 offset:6144
    v_mfma_f32_32x32x16_bf16 v[80:95], v[176:179], v[172:175], v[80:95]
    ds_read_b128 v[208:211], v19 offset:36864
    ds_read_b64_tr_b16 v[214:215], v29 offset:6656
    s_waitcnt lgkmcnt(8)
    v_mfma_f32_32x32x16_bf16 v[64:79], v[188:191], v[180:183], v[64:79]
    ds_read_b128 v[168:171], v20 offset:32768
    ds_read_b64_tr_b16 v[176:177], v28 offset:0
    v_mfma_f32_32x32x16_bf16 v[80:95], v[188:191], v[184:187], v[80:95]
    ds_read_b128 v[172:175], v20 offset:36864
    ds_read_b64_tr_b16 v[178:179], v28 offset:512
    s_waitcnt lgkmcnt(8)
    v_mfma_f32_32x32x16_bf16 v[64:79], v[200:203], v[192:195], v[64:79]
    ds_read_b128 v[180:183], v21 offset:32768
    ds_read_b64_tr_b16 v[188:189], v28 offset:2048
    v_mfma_f32_32x32x16_bf16 v[80:95], v[200:203], v[196:199], v[80:95]
    ds_read_b128 v[184:187], v21 offset:36864
    ds_read_b64_tr_b16 v[190:191], v28 offset:2560
    s_waitcnt lgkmcnt(8)
    v_mfma_f32_32x32x16_bf16 v[64:79], v[212:215], v[204:207], v[64:79]
    ds_read_b128 v[192:195], v22 offset:32768
    ds_read_b64_tr_b16 v[200:201], v28 offset:4096
    v_mfma_f32_32x32x16_bf16 v[80:95], v[212:215], v[208:211], v[80:95]
    ds_read_b128 v[196:199], v22 offset:36864
    ds_read_b64_tr_b16 v[202:203], v28 offset:4608
    s_waitcnt lgkmcnt(8)
    v_mfma_f32_32x32x16_bf16 v[64:79], v[176:179], v[168:171], v[64:79]
    ds_read_b128 v[204:207], v23 offset:32768
    ds_read_b64_tr_b16 v[212:213], v28 offset:6144
    v_mfma_f32_32x32x16_bf16 v[80:95], v[176:179], v[172:175], v[80:95]
    ds_read_b128 v[208:211], v23 offset:36864
    ds_read_b64_tr_b16 v[214:215], v28 offset:6656
    s_waitcnt lgkmcnt(8)
    v_mfma_f32_32x32x16_bf16 v[64:79], v[188:191], v[180:183], v[64:79]
    ds_read_b128 v[168:171], v16 offset:49152
    ds_read_b64_tr_b16 v[176:177], v28 offset:8192
    v_mfma_f32_32x32x16_bf16 v[80:95], v[188:191], v[184:187], v[80:95]
    ds_read_b128 v[172:175], v16 offset:53248
    ds_read_b64_tr_b16 v[178:179], v28 offset:8704
    s_waitcnt lgkmcnt(8)
    v_mfma_f32_32x32x16_bf16 v[64:79], v[200:203], v[192:195], v[64:79]
    ds_read_b128 v[180:183], v17 offset:49152
    ds_read_b64_tr_b16 v[188:189], v28 offset:10240
    v_mfma_f32_32x32x16_bf16 v[80:95], v[200:203], v[196:199], v[80:95]
    ds_read_b128 v[184:187], v17 offset:53248
    ds_read_b64_tr_b16 v[190:191], v28 offset:10752
    s_waitcnt lgkmcnt(8)
    v_mfma_f32_32x32x16_bf16 v[64:79], v[212:215], v[204:207], v[64:79]
    ds_read_b128 v[192:195], v18 offset:49152
    ds_read_b64_tr_b16 v[200:201], v28 offset:12288
    v_mfma_f32_32x32x16_bf16 v[80:95], v[212:215], v[208:211], v[80:95]
    ds_read_b128 v[196:199], v18 offset:53248
    ds_read_b64_tr_b16 v[202:203], v28 offset:12800
    s_waitcnt lgkmcnt(8)
    v_mfma_f32_32x32x16_bf16 v[64:79], v[176:179], v[168:171], v[64:79]
    s_barrier
    ds_read_b128 v[204:207], v19 offset:49152
    ds_read_b64_tr_b16 v[212:213], v28 offset:14336
    v_mfma_f32_32x32x16_bf16 v[80:95], v[176:179], v[172:175], v[80:95]
    ds_read_b128 v[208:211], v19 offset:53248
    ds_read_b64_tr_b16 v[214:215], v28 offset:14848
    s_waitcnt lgkmcnt(8)
    v_mfma_f32_32x32x16_bf16 v[64:79], v[188:191], v[180:183], v[64:79]
    ds_read_b128 v[168:171], v24 offset:0
    ds_read_b64_tr_b16 v[176:177], v29 offset:8192
    v_mfma_f32_32x32x16_bf16 v[80:95], v[188:191], v[184:187], v[80:95]
    ds_read_b128 v[172:175], v24 offset:4096
    ds_read_b64_tr_b16 v[178:179], v29 offset:8704
    s_waitcnt lgkmcnt(8)
    v_mfma_f32_32x32x16_bf16 v[64:79], v[200:203], v[192:195], v[64:79]
    ds_read_b128 v[180:183], v25 offset:0
    ds_read_b64_tr_b16 v[188:189], v29 offset:10240
    v_mfma_f32_32x32x16_bf16 v[80:95], v[200:203], v[196:199], v[80:95]
    ds_read_b128 v[184:187], v25 offset:4096
    ds_read_b64_tr_b16 v[190:191], v29 offset:10752
    s_waitcnt lgkmcnt(8)
    v_mfma_f32_32x32x16_bf16 v[64:79], v[212:215], v[204:207], v[64:79]
    ds_read_b128 v[192:195], v26 offset:0
    ds_read_b64_tr_b16 v[200:201], v29 offset:12288
    v_mfma_f32_32x32x16_bf16 v[80:95], v[212:215], v[208:211], v[80:95]
    ds_read_b128 v[196:199], v26 offset:4096
    ds_read_b64_tr_b16 v[202:203], v29 offset:12800
    s_waitcnt lgkmcnt(8)
    v_mfma_f32_32x32x16_bf16 v[64:79], v[176:179], v[168:171], v[64:79]
    ds_read_b128 v[204:207], v27 offset:0
    ds_read_b64_tr_b16 v[212:213], v29 offset:14336
    v_mfma_f32_32x32x16_bf16 v[80:95], v[176:179], v[172:175], v[80:95]
    ds_read_b128 v[208:211], v27 offset:4096
    ds_read_b64_tr_b16 v[214:215], v29 offset:14848
    s_waitcnt lgkmcnt(8)
    v_mfma_f32_32x32x16_bf16 v[64:79], v[188:191], v[180:183], v[64:79]
    v_mfma_f32_32x32x16_bf16 v[80:95], v[188:191], v[184:187], v[80:95]
    s_waitcnt lgkmcnt(4)
    v_mfma_f32_32x32x16_bf16 v[64:79], v[200:203], v[192:195], v[64:79]
    v_mfma_f32_32x32x16_bf16 v[80:95], v[200:203], v[196:199], v[80:95]
    s_waitcnt lgkmcnt(0)
    v_mfma_f32_32x32x16_bf16 v[64:79], v[212:215], v[204:207], v[64:79]
    v_mfma_f32_32x32x16_bf16 v[80:95], v[212:215], v[208:211], v[80:95]
    s_nop 10
    v_pk_mul_f32 v[96:97], v[64:65], s[64:65]
    v_pk_mul_f32 v[98:99], v[66:67], s[64:65]
    v_pk_mul_f32 v[100:101], v[68:69], s[64:65]
    v_pk_mul_f32 v[102:103], v[70:71], s[64:65]
    v_pk_mul_f32 v[104:105], v[72:73], s[64:65]
    v_pk_mul_f32 v[106:107], v[74:75], s[64:65]
    v_pk_mul_f32 v[108:109], v[76:77], s[64:65]
    v_pk_mul_f32 v[110:111], v[78:79], s[64:65]
    v_exp_f32 v96, v96 clamp
    v_max_f32 v64, s66, v64
    v_exp_f32 v97, v97 clamp
    v_max_f32 v65, s66, v65
    v_exp_f32 v98, v98 clamp
    v_max_f32 v66, s66, v66
    v_exp_f32 v99, v99 clamp
    v_max_f32 v67, s66, v67
    v_exp_f32 v100, v100 clamp
    v_max_f32 v68, s66, v68
    v_exp_f32 v101, v101 clamp
    v_max_f32 v69, s66, v69
    v_exp_f32 v102, v102 clamp
    v_max_f32 v70, s66, v70
    v_exp_f32 v103, v103 clamp
    v_max_f32 v71, s66, v71
    v_exp_f32 v104, v104 clamp
    v_max_f32 v72, s66, v72
    v_exp_f32 v105, v105 clamp
    v_max_f32 v73, s66, v73
    v_exp_f32 v106, v106 clamp
    v_max_f32 v74, s66, v74
    v_exp_f32 v107, v107 clamp
    v_max_f32 v75, s66, v75
    v_exp_f32 v108, v108 clamp
    v_max_f32 v76, s66, v76
    v_exp_f32 v109, v109 clamp
    v_max_f32 v77, s66, v77
    v_exp_f32 v110, v110 clamp
    v_max_f32 v78, s66, v78
    v_exp_f32 v111, v111 clamp
    v_max_f32 v79, s66, v79
    v_pk_add_f32 v[64:65], v[64:65], v[96:97]
    v_pk_add_f32 v[66:67], v[66:67], v[98:99]
    v_pk_add_f32 v[68:69], v[68:69], v[100:101]
    v_pk_add_f32 v[70:71], v[70:71], v[102:103]
    v_pk_add_f32 v[72:73], v[72:73], v[104:105]
    v_pk_add_f32 v[74:75], v[74:75], v[106:107]
    v_pk_add_f32 v[76:77], v[76:77], v[108:109]
    v_pk_add_f32 v[78:79], v[78:79], v[110:111]
    v_cvt_pk_bf16_f32 v32, v64, v65
    v_cvt_pk_bf16_f32 v33, v66, v67
    v_cvt_pk_bf16_f32 v34, v68, v69
    v_cvt_pk_bf16_f32 v35, v70, v71
    v_cvt_pk_bf16_f32 v36, v72, v73
    v_cvt_pk_bf16_f32 v37, v74, v75
    v_cvt_pk_bf16_f32 v38, v76, v77
    v_cvt_pk_bf16_f32 v39, v78, v79
    global_store_dwordx4 v2, v[32:35], s[70:71] sc0 sc1
    global_store_dwordx4 v2, v[36:39], s[70:71] offset:1024 sc0 sc1
    v_pk_mul_f32 v[96:97], v[80:81], s[64:65]
    v_pk_mul_f32 v[98:99], v[82:83], s[64:65]
    v_pk_mul_f32 v[100:101], v[84:85], s[64:65]
    v_pk_mul_f32 v[102:103], v[86:87], s[64:65]
    v_pk_mul_f32 v[104:105], v[88:89], s[64:65]
    v_pk_mul_f32 v[106:107], v[90:91], s[64:65]
    v_pk_mul_f32 v[108:109], v[92:93], s[64:65]
    v_pk_mul_f32 v[110:111], v[94:95], s[64:65]
    v_exp_f32 v96, v96 clamp
    v_max_f32 v80, s66, v80
    v_exp_f32 v97, v97 clamp
    v_max_f32 v81, s66, v81
    v_exp_f32 v98, v98 clamp
    v_max_f32 v82, s66, v82
    v_exp_f32 v99, v99 clamp
    v_max_f32 v83, s66, v83
    v_exp_f32 v100, v100 clamp
    v_max_f32 v84, s66, v84
    v_exp_f32 v101, v101 clamp
    v_max_f32 v85, s66, v85
    v_exp_f32 v102, v102 clamp
    v_max_f32 v86, s66, v86
    v_exp_f32 v103, v103 clamp
    v_max_f32 v87, s66, v87
    v_exp_f32 v104, v104 clamp
    v_max_f32 v88, s66, v88
    v_exp_f32 v105, v105 clamp
    v_max_f32 v89, s66, v89
    v_exp_f32 v106, v106 clamp
    v_max_f32 v90, s66, v90
    v_exp_f32 v107, v107 clamp
    v_max_f32 v91, s66, v91
    v_exp_f32 v108, v108 clamp
    v_max_f32 v92, s66, v92
    v_exp_f32 v109, v109 clamp
    v_max_f32 v93, s66, v93
    v_exp_f32 v110, v110 clamp
    v_max_f32 v94, s66, v94
    v_exp_f32 v111, v111 clamp
    v_max_f32 v95, s66, v95
    v_pk_add_f32 v[80:81], v[80:81], v[96:97]
    v_pk_add_f32 v[82:83], v[82:83], v[98:99]
    v_pk_add_f32 v[84:85], v[84:85], v[100:101]
    v_pk_add_f32 v[86:87], v[86:87], v[102:103]
    v_pk_add_f32 v[88:89], v[88:89], v[104:105]
    v_pk_add_f32 v[90:91], v[90:91], v[106:107]
    v_pk_add_f32 v[92:93], v[92:93], v[108:109]
    v_pk_add_f32 v[94:95], v[94:95], v[110:111]
    v_cvt_pk_bf16_f32 v40, v80, v81
    v_cvt_pk_bf16_f32 v41, v82, v83
    v_cvt_pk_bf16_f32 v42, v84, v85
    v_cvt_pk_bf16_f32 v43, v86, v87
    v_cvt_pk_bf16_f32 v44, v88, v89
    v_cvt_pk_bf16_f32 v45, v90, v91
    v_cvt_pk_bf16_f32 v46, v92, v93
    v_cvt_pk_bf16_f32 v47, v94, v95
    global_store_dwordx4 v3, v[40:43], s[70:71] sc0 sc1
    global_store_dwordx4 v3, v[44:47], s[70:71] offset:1024 sc0 sc1
    s_endpgm
    s_nop 0
A_setA:
    s_lshr_b32 s50, s49, 1
    s_and_b32 s51, s49, 1
    v_and_b32 v10, 31, v1
    v_lshrrev_b32 v11, 5, v1
    v_bfe_u32 v12, v10, 1, 3
    v_xor_b32 v12, v12, v11
    s_lshl_b32 s47, s50, 13
    v_lshl_add_u32 v13, v10, 7, s47
    v_xor_b32 v14, 0, v12
    v_lshl_add_u32 v16, v14, 4, v13
    v_add_u32 v20, 0x10000, v16
    v_add_u32 v24, 0x20000, v16
    v_xor_b32 v14, 2, v12
    v_lshl_add_u32 v17, v14, 4, v13
    v_add_u32 v21, 0x10000, v17
    v_add_u32 v25, 0x20000, v17
    v_xor_b32 v14, 4, v12
    v_lshl_add_u32 v18, v14, 4, v13
    v_add_u32 v22, 0x10000, v18
    v_add_u32 v26, 0x20000, v18
    v_xor_b32 v14, 6, v12
    v_lshl_add_u32 v19, v14, 4, v13
    v_add_u32 v23, 0x10000, v19
    v_add_u32 v27, 0x20000, v19
    v_bfe_u32 v10, v1, 2, 2
    v_lshl_add_u32 v12, v11, 3, v10
    v_lshlrev_b32 v12, 7, v12
    v_bfe_u32 v13, v1, 4, 1
    v_bfe_u32 v14, v1, 1, 1
    v_lshl_add_u32 v13, v13, 1, v14
    v_bfe_u32 v14, v1, 3, 1
    v_xor_b32 v14, s51, v14
    v_lshl_add_u32 v13, v14, 2, v13
    v_lshl_add_u32 v12, v13, 4, v12
    v_and_b32 v14, 1, v1
    v_lshl_add_u32 v28, v14, 3, v12
    v_add_u32 v29, 114688, v28
    s_mov_b32 s64, 0x3fb8aa3b
    s_mov_b32 s65, 0x3fb8aa3b
    s_mov_b32 s66, 0x358637bd
    s_waitcnt lgkmcnt(0)
    s_mov_b32 s52, s16
    s_mov_b32 s53, s17
    s_mov_b32 s56, s18
    s_mov_b32 s57, s19
    s_mul_i32 s47, s45, 4352
    s_add_u32 s47, s47, 4194304
    s_add_u32 s60, s42, s47
    s_addc_u32 s61, s43, 0
    s_mov_b32 s62, 4352
    s_mov_b32 s63, 0x00020000
    s_lshl_b32 s47, s45, 2
    v_mov_b32 v5, s47
    s_or_b32 s47, s44, s5
    s_cmp_eq_u32 s47, 0
    s_cbranch_scc0 A_nozero
    v_mov_b32 v32, 0
    v_mov_b32 v33, 0
    v_mov_b32 v34, 0
    v_mov_b32 v35, 0
    v_lshlrev_b32 v10, 4, v1
    buffer_store_dwordx4 v[32:35], v10, s[60:63], 0 offen offset:0 sc0 sc1
    buffer_store_dwordx4 v[32:35], v10, s[60:63], 0 offen offset:1024 sc0 sc1
    buffer_store_dwordx4 v[32:35], v10, s[60:63], 0 offen offset:2048 sc0 sc1
    buffer_store_dwordx4 v[32:35], v10, s[60:63], 0 offen offset:3072 sc0 sc1
    v_add_u32 v11, 4096, v10
    buffer_store_dwordx4 v[32:35], v11, s[60:63], 0 offen sc0 sc1
    s_waitcnt vmcnt(0)
    s_nop 0
    v_mov_b32 v11, 1
    global_store_dword v5, v11, s[40:41] sc0 sc1
    s_nop 1
A_nozero:
    v_mov_b32 v64, s66
    v_mov_b32 v65, s66
    v_mov_b32 v66, s66
    v_mov_b32 v67, s66
    v_mov_b32 v68, s66
    v_mov_b32 v69, s66
    v_mov_b32 v70, s66
    v_mov_b32 v71, s66
    v_mov_b32 v72, s66
    v_mov_b32 v73, s66
    v_mov_b32 v74, s66
    v_mov_b32 v75, s66
    v_mov_b32 v76, s66
    v_mov_b32 v77, s66
    v_mov_b32 v78, s66
    v_mov_b32 v79, s66
    v_mov_b32 v80, s66
    v_mov_b32 v81, s66
    v_mov_b32 v82, s66
    v_mov_b32 v83, s66
    v_mov_b32 v84, s66
    v_mov_b32 v85, s66
    v_mov_b32 v86, s66
    v_mov_b32 v87, s66
    v_mov_b32 v88, s66
    v_mov_b32 v89, s66
    v_mov_b32 v90, s66
    v_mov_b32 v91, s66
    v_mov_b32 v92, s66
    v_mov_b32 v93, s66
    v_mov_b32 v94, s66
    v_mov_b32 v95, s66
    v_bfe_u32 v10, v1, 4, 1
    v_cmp_eq_u32 s[68:69], 1, v10
    v_lshrrev_b32 v11, 5, v1
    v_lshl_add_u32 v11, v10, 1, v11
    s_lshl_b32 s47, s51, 2
    v_add_u32 v11, s47, v11
    v_and_b32 v12, 15, v1
    v_lshl_add_u32 v13, v11, 5, v12
    s_mul_i32 s47, s50, 4352
    s_add_u32 s47, s47, 65536
    v_lshl_add_u32 v30, v13, 4, s47
    v_lshl_add_u32 v31, v11, 5, s47
    v_lshlrev_b32 v6, 2, v0
    v_add_u32 v7, 4096, v6
    v_add_u32 v8, 65536, v6
    v_mov_b32 v4, 1
    s_barrier
    ds_read_b128 v[128:131], v16 offset:0
    ds_read_b64_tr_b16 v[136:137], v29 offset:0
    ds_read_b64_tr_b16 v[138:139], v29 offset:512
    ds_read_b64_tr_b16 v[140:141], v29 offset:8192
    ds_read_b64_tr_b16 v[142:143], v29 offset:8704
    ds_read_b128 v[132:135], v16 offset:4096
    ds_read_b128 v[144:147], v17 offset:0
    ds_read_b64_tr_b16 v[152:153], v29 offset:2048
    ds_read_b64_tr_b16 v[154:155], v29 offset:2560
    ds_read_b64_tr_b16 v[156:157], v29 offset:10240
    ds_read_b64_tr_b16 v[158:159], v29 offset:10752
    ds_read_b128 v[148:151], v17 offset:4096
    s_waitcnt lgkmcnt(9)
    v_mfma_f32_32x32x16_bf16 v[64:79], v[128:131], v[136:139], v[64:79]
    ds_read_b128 v[160:163], v18 offset:0
    ds_read_b64_tr_b16 v[168:169], v29 offset:4096
    s_waitcnt lgkmcnt(9)
    v_mfma_f32_32x32x16_bf16 v[96:111], v[128:131], v[140:143], 0
    ds_read_b64_tr_b16 v[170:171], v29 offset:4608
    s_waitcnt lgkmcnt(9)
    v_mfma_f32_32x32x16_bf16 v[80:95], v[132:135], v[136:139], v[80:95]
    ds_read_b64_tr_b16 v[172:173], v29 offset:12288
    ds_read_b64_tr_b16 v[174:175], v29 offset:12800
    v_mfma_f32_32x32x16_bf16 v[112:127], v[132:135], v[140:143], 0
    ds_read_b128 v[164:167], v18 offset:4096
    s_waitcnt lgkmcnt(9)
    v_mfma_f32_32x32x16_bf16 v[64:79], v[144:147], v[152:155], v[64:79]
    ds_read_b128 v[176:179], v19 offset:0
    ds_read_b64_tr_b16 v[184:185], v29 offset:6144
    s_waitcnt lgkmcnt(9)
    v_mfma_f32_32x32x16_bf16 v[96:111], v[144:147], v[156:159], v[96:111]
    ds_read_b64_tr_b16 v[186:187], v29 offset:6656
    s_waitcnt lgkmcnt(9)
    v_mfma_f32_32x32x16_bf16 v[80:95], v[148:151], v[152:155], v[80:95]
    ds_read_b64_tr_b16 v[188:189], v29 offset:14336
    ds_read_b64_tr_b16 v[190:191], v29 offset:14848
    v_mfma_f32_32x32x16_bf16 v[112:127], v[148:151], v[156:159], v[112:127]
    ds_read_b128 v[180:183], v19 offset:4096
    s_waitcnt lgkmcnt(9)
    v_mfma_f32_32x32x16_bf16 v[64:79], v[160:163], v[168:171], v[64:79]
    s_waitcnt lgkmcnt(7)
    v_mfma_f32_32x32x16_bf16 v[96:111], v[160:163], v[172:175], v[96:111]
    s_waitcnt lgkmcnt(0)
    s_barrier
    ds_read_b128 v[128:131], v16 offset:16384
    ds_read_b64_tr_b16 v[136:137], v29 offset:16384
    v_mfma_f32_32x32x16_bf16 v[80:95], v[164:167], v[168:171], v[80:95]
    ds_read_b64_tr_b16 v[138:139], v29 offset:16896
    ds_read_b64_tr_b16 v[140:141], v29 offset:24576
    ds_read_b64_tr_b16 v[142:143], v29 offset:25088
    v_mfma_f32_32x32x16_bf16 v[112:127], v[164:167], v[172:175], v[112:127]
    ds_read_b128 v[132:135], v16 offset:20480
    ds_read_b128 v[144:147], v17 offset:16384
    v_mfma_f32_32x32x16_bf16 v[64:79], v[176:179], v[184:187], v[64:79]
    ds_read_b64_tr_b16 v[152:153], v29 offset:18432
    ds_read_b64_tr_b16 v[154:155], v29 offset:18944
    ds_read_b64_tr_b16 v[156:157], v29 offset:26624
    v_mfma_f32_32x32x16_bf16 v[96:111], v[176:179], v[188:191], v[96:111]
    ds_read_b64_tr_b16 v[158:159], v29 offset:27136
    ds_read_b128 v[148:151], v17 offset:20480
    v_mfma_f32_32x32x16_bf16 v[80:95], v[180:183], v[184:187], v[80:95]
    v_mfma_f32_32x32x16_bf16 v[112:127], v[180:183], v[188:191], v[112:127]
    ds_read_b128 v[160:163], v18 offset:16384
    ds_read_b64_tr_b16 v[168:169], v29 offset:20480
    s_waitcnt lgkmcnt(11)
    v_mfma_f32_32x32x16_bf16 v[64:79], v[128:131], v[136:139], v[64:79]
    ds_read_b64_tr_b16 v[170:171], v29 offset:20992
    ds_read_b64_tr_b16 v[172:173], v29 offset:28672
    s_waitcnt lgkmcnt(11)
    v_mfma_f32_32x32x16_bf16 v[96:111], v[128:131], v[140:143], v[96:111]
    ds_read_b64_tr_b16 v[174:175], v29 offset:29184
    s_waitcnt lgkmcnt(11)
    v_mfma_f32_32x32x16_bf16 v[80:95], v[132:135], v[136:139], v[80:95]
    ds_read_b128 v[164:167], v18 offset:20480
    v_mfma_f32_32x32x16_bf16 v[112:127], v[132:135], v[140:143], v[112:127]
    ds_read_b128 v[176:179], v19 offset:16384
    s_waitcnt lgkmcnt(10)
    v_mfma_f32_32x32x16_bf16 v[64:79], v[144:147], v[152:155], v[64:79]
    ds_read_b64_tr_b16 v[184:185], v29 offset:22528
    ds_read_b64_tr_b16 v[186:187], v29 offset:23040
    s_waitcnt lgkmcnt(10)
    v_mfma_f32_32x32x16_bf16 v[96:111], v[144:147], v[156:159], v[96:111]
    ds_read_b64_tr_b16 v[188:189], v29 offset:30720
    s_waitcnt lgkmcnt(10)
    v_mfma_f32_32x32x16_bf16 v[80:95], v[148:151], v[152:155], v[80:95]
    ds_read_b64_tr_b16 v[190:191], v29 offset:31232
    ds_read_b128 v[180:183], v19 offset:20480
    v_mfma_f32_32x32x16_bf16 v[112:127], v[148:151], v[156:159], v[112:127]
    s_waitcnt lgkmcnt(9)
    v_mfma_f32_32x32x16_bf16 v[64:79], v[160:163], v[168:171], v[64:79]
    s_waitcnt lgkmcnt(7)
    v_mfma_f32_32x32x16_bf16 v[96:111], v[160:163], v[172:175], v[96:111]
    s_waitcnt lgkmcnt(0)
    s_barrier
    ds_read_b128 v[128:131], v16 offset:32768
    ds_read_b64_tr_b16 v[136:137], v29 offset:32768
    v_mfma_f32_32x32x16_bf16 v[80:95], v[164:167], v[168:171], v[80:95]
    ds_read_b64_tr_b16 v[138:139], v29 offset:33280
    ds_read_b64_tr_b16 v[140:141], v29 offset:40960
    ds_read_b64_tr_b16 v[142:143], v29 offset:41472
    v_mfma_f32_32x32x16_bf16 v[112:127], v[164:167], v[172:175], v[112:127]
    ds_read_b128 v[132:135], v16 offset:36864
    ds_read_b128 v[144:147], v17 offset:32768
    v_mfma_f32_32x32x16_bf16 v[64:79], v[176:179], v[184:187], v[64:79]
    ds_read_b64_tr_b16 v[152:153], v29 offset:34816
    ds_read_b64_tr_b16 v[154:155], v29 offset:35328
    ds_read_b64_tr_b16 v[156:157], v29 offset:43008
    v_mfma_f32_32x32x16_bf16 v[96:111], v[176:179], v[188:191], v[96:111]
    ds_read_b64_tr_b16 v[158:159], v29 offset:43520
    ds_read_b128 v[148:151], v17 offset:36864
    v_mfma_f32_32x32x16_bf16 v[80:95], v[180:183], v[184:187], v[80:95]
    v_mfma_f32_32x32x16_bf16 v[112:127], v[180:183], v[188:191], v[112:127]
    ds_read_b128 v[160:163], v18 offset:32768
    ds_read_b64_tr_b16 v[168:169], v29 offset:36864
    s_waitcnt lgkmcnt(11)
    v_mfma_f32_32x32x16_bf16 v[64:79], v[128:131], v[136:139], v[64:79]
    ds_read_b64_tr_b16 v[170:171], v29 offset:37376
    ds_read_b64_tr_b16 v[172:173], v29 offset:45056
    s_waitcnt lgkmcnt(11)
    v_mfma_f32_32x32x16_bf16 v[96:111], v[128:131], v[140:143], v[96:111]
    ds_read_b64_tr_b16 v[174:175], v29 offset:45568
    s_waitcnt lgkmcnt(11)
    v_mfma_f32_32x32x16_bf16 v[80:95], v[132:135], v[136:139], v[80:95]
    ds_read_b128 v[164:167], v18 offset:36864
    v_mfma_f32_32x32x16_bf16 v[112:127], v[132:135], v[140:143], v[112:127]
    ds_read_b128 v[176:179], v19 offset:32768
    s_waitcnt lgkmcnt(10)
    v_mfma_f32_32x32x16_bf16 v[64:79], v[144:147], v[152:155], v[64:79]
    ds_read_b64_tr_b16 v[184:185], v29 offset:38912
    ds_read_b64_tr_b16 v[186:187], v29 offset:39424
    s_waitcnt lgkmcnt(10)
    v_mfma_f32_32x32x16_bf16 v[96:111], v[144:147], v[156:159], v[96:111]
    ds_read_b64_tr_b16 v[188:189], v29 offset:47104
    s_waitcnt lgkmcnt(10)
    v_mfma_f32_32x32x16_bf16 v[80:95], v[148:151], v[152:155], v[80:95]
    ds_read_b64_tr_b16 v[190:191], v29 offset:47616
    ds_read_b128 v[180:183], v19 offset:36864
    v_mfma_f32_32x32x16_bf16 v[112:127], v[148:151], v[156:159], v[112:127]
    s_waitcnt lgkmcnt(9)
    v_mfma_f32_32x32x16_bf16 v[64:79], v[160:163], v[168:171], v[64:79]
    s_waitcnt lgkmcnt(7)
    v_mfma_f32_32x32x16_bf16 v[96:111], v[160:163], v[172:175], v[96:111]
    s_waitcnt lgkmcnt(0)
    s_barrier
    ds_read_b128 v[128:131], v16 offset:49152
    ds_read_b64_tr_b16 v[136:137], v29 offset:0
    v_mfma_f32_32x32x16_bf16 v[80:95], v[164:167], v[168:171], v[80:95]
    ds_read_b64_tr_b16 v[138:139], v29 offset:512
    ds_read_b64_tr_b16 v[140:141], v29 offset:8192
    ds_read_b64_tr_b16 v[142:143], v29 offset:8704
    v_mfma_f32_32x32x16_bf16 v[112:127], v[164:167], v[172:175], v[112:127]
    ds_read_b128 v[132:135], v16 offset:53248
    ds_read_b128 v[144:147], v17 offset:49152
    v_mfma_f32_32x32x16_bf16 v[64:79], v[176:179], v[184:187], v[64:79]
    ds_read_b64_tr_b16 v[152:153], v29 offset:2048
    ds_read_b64_tr_b16 v[154:155], v29 offset:2560
    ds_read_b64_tr_b16 v[156:157], v29 offset:10240
    v_mfma_f32_32x32x16_bf16 v[96:111], v[176:179], v[188:191], v[96:111]
    ds_read_b64_tr_b16 v[158:159], v29 offset:10752
    ds_read_b128 v[148:151], v17 offset:53248
    v_mfma_f32_32x32x16_bf16 v[80:95], v[180:183], v[184:187], v[80:95]
    v_mfma_f32_32x32x16_bf16 v[112:127], v[180:183], v[188:191], v[112:127]
    ds_read_b128 v[160:163], v18 offset:49152
    ds_read_b64_tr_b16 v[168:169], v29 offset:4096
    s_waitcnt lgkmcnt(11)
    v_mfma_f32_32x32x16_bf16 v[64:79], v[128:131], v[136:139], v[64:79]
    ds_read_b64_tr_b16 v[170:171], v29 offset:4608
    ds_read_b64_tr_b16 v[172:173], v29 offset:12288
    s_waitcnt lgkmcnt(11)
    v_mfma_f32_32x32x16_bf16 v[96:111], v[128:131], v[140:143], v[96:111]
    ds_read_b64_tr_b16 v[174:175], v29 offset:12800
    s_waitcnt lgkmcnt(11)
    v_mfma_f32_32x32x16_bf16 v[80:95], v[132:135], v[136:139], v[80:95]
    ds_read_b128 v[164:167], v18 offset:53248
    v_mfma_f32_32x32x16_bf16 v[112:127], v[132:135], v[140:143], v[112:127]
    ds_read_b128 v[176:179], v19 offset:49152
    s_waitcnt lgkmcnt(10)
    v_mfma_f32_32x32x16_bf16 v[64:79], v[144:147], v[152:155], v[64:79]
    ds_read_b64_tr_b16 v[184:185], v29 offset:6144
    ds_read_b64_tr_b16 v[186:187], v29 offset:6656
    s_waitcnt lgkmcnt(10)
    v_mfma_f32_32x32x16_bf16 v[96:111], v[144:147], v[156:159], v[96:111]
    ds_read_b64_tr_b16 v[188:189], v29 offset:14336
    s_waitcnt lgkmcnt(10)
    v_mfma_f32_32x32x16_bf16 v[80:95], v[148:151], v[152:155], v[80:95]
    ds_read_b64_tr_b16 v[190:191], v29 offset:14848
    ds_read_b128 v[180:183], v19 offset:53248
    v_mfma_f32_32x32x16_bf16 v[112:127], v[148:151], v[156:159], v[112:127]
    s_waitcnt lgkmcnt(9)
    v_mfma_f32_32x32x16_bf16 v[64:79], v[160:163], v[168:171], v[64:79]
    s_waitcnt lgkmcnt(7)
    v_mfma_f32_32x32x16_bf16 v[96:111], v[160:163], v[172:175], v[96:111]
    s_waitcnt lgkmcnt(0)
    s_barrier
    ds_read_b128 v[128:131], v20 offset:0
    ds_read_b64_tr_b16 v[136:137], v29 offset:16384
    v_mfma_f32_32x32x16_bf16 v[80:95], v[164:167], v[168:171], v[80:95]
    ds_read_b64_tr_b16 v[138:139], v29 offset:16896
    ds_read_b64_tr_b16 v[140:141], v29 offset:24576
    ds_read_b64_tr_b16 v[142:143], v29 offset:25088
    v_mfma_f32_32x32x16_bf16 v[112:127], v[164:167], v[172:175], v[112:127]
    ds_read_b128 v[132:135], v20 offset:4096
    ds_read_b128 v[144:147], v21 offset:0
    v_mfma_f32_32x32x16_bf16 v[64:79], v[176:179], v[184:187], v[64:79]
    ds_read_b64_tr_b16 v[152:153], v29 offset:18432
    ds_read_b64_tr_b16 v[154:155], v29 offset:18944
    ds_read_b64_tr_b16 v[156:157], v29 offset:26624
    v_mfma_f32_32x32x16_bf16 v[96:111], v[176:179], v[188:191], v[96:111]
    ds_read_b64_tr_b16 v[158:159], v29 offset:27136
    ds_read_b128 v[148:151], v21 offset:4096
    v_mfma_f32_32x32x16_bf16 v[80:95], v[180:183], v[184:187], v[80:95]
    v_mfma_f32_32x32x16_bf16 v[112:127], v[180:183], v[188:191], v[112:127]
    ds_read_b128 v[160:163], v22 offset:0
    ds_read_b64_tr_b16 v[168:169], v29 offset:20480
    s_waitcnt lgkmcnt(11)
    v_mfma_f32_32x32x16_bf16 v[64:79], v[128:131], v[136:139], v[64:79]
    ds_read_b64_tr_b16 v[170:171], v29 offset:20992
    ds_read_b64_tr_b16 v[172:173], v29 offset:28672
    s_waitcnt lgkmcnt(11)
    v_mfma_f32_32x32x16_bf16 v[96:111], v[128:131], v[140:143], v[96:111]
    ds_read_b64_tr_b16 v[174:175], v29 offset:29184
    s_waitcnt lgkmcnt(11)
    v_mfma_f32_32x32x16_bf16 v[80:95], v[132:135], v[136:139], v[80:95]
    ds_read_b128 v[164:167], v22 offset:4096
    v_mfma_f32_32x32x16_bf16 v[112:127], v[132:135], v[140:143], v[112:127]
    ds_read_b128 v[176:179], v23 offset:0
    s_waitcnt lgkmcnt(10)
    v_mfma_f32_32x32x16_bf16 v[64:79], v[144:147], v[152:155], v[64:79]
    ds_read_b64_tr_b16 v[184:185], v29 offset:22528
    ds_read_b64_tr_b16 v[186:187], v29 offset:23040
    s_waitcnt lgkmcnt(10)
    v_mfma_f32_32x32x16_bf16 v[96:111], v[144:147], v[156:159], v[96:111]
    ds_read_b64_tr_b16 v[188:189], v29 offset:30720
    s_waitcnt lgkmcnt(10)
    v_mfma_f32_32x32x16_bf16 v[80:95], v[148:151], v[152:155], v[80:95]
    ds_read_b64_tr_b16 v[190:191], v29 offset:31232
    ds_read_b128 v[180:183], v23 offset:4096
    v_mfma_f32_32x32x16_bf16 v[112:127], v[148:151], v[156:159], v[112:127]
    s_waitcnt lgkmcnt(9)
    v_mfma_f32_32x32x16_bf16 v[64:79], v[160:163], v[168:171], v[64:79]
    s_waitcnt lgkmcnt(7)
    v_mfma_f32_32x32x16_bf16 v[96:111], v[160:163], v[172:175], v[96:111]
    s_waitcnt lgkmcnt(0)
    s_barrier
    s_cmp_eq_u32 s49, 1
    s_cbranch_scc0 A_nf
    global_load_dword v4, v5, s[40:41] sc0 sc1
A_nf:
    ds_read_b128 v[128:131], v20 offset:16384
    ds_read_b64_tr_b16 v[136:137], v29 offset:32768
    v_mfma_f32_32x32x16_bf16 v[80:95], v[164:167], v[168:171], v[80:95]
    ds_read_b64_tr_b16 v[138:139], v29 offset:33280
    ds_read_b64_tr_b16 v[140:141], v29 offset:40960
    ds_read_b64_tr_b16 v[142:143], v29 offset:41472
    v_mfma_f32_32x32x16_bf16 v[112:127], v[164:167], v[172:175], v[112:127]
    ds_read_b128 v[132:135], v20 offset:20480
    ds_read_b128 v[144:147], v21 offset:16384
    v_mfma_f32_32x32x16_bf16 v[64:79], v[176:179], v[184:187], v[64:79]
    ds_read_b64_tr_b16 v[152:153], v29 offset:34816
    ds_read_b64_tr_b16 v[154:155], v29 offset:35328
    ds_read_b64_tr_b16 v[156:157], v29 offset:43008
    v_mfma_f32_32x32x16_bf16 v[96:111], v[176:179], v[188:191], v[96:111]
    ds_read_b64_tr_b16 v[158:159], v29 offset:43520
    ds_read_b128 v[148:151], v21 offset:20480
    v_mfma_f32_32x32x16_bf16 v[80:95], v[180:183], v[184:187], v[80:95]
    v_mfma_f32_32x32x16_bf16 v[112:127], v[180:183], v[188:191], v[112:127]
    ds_read_b128 v[160:163], v22 offset:16384
    ds_read_b64_tr_b16 v[168:169], v29 offset:36864
    s_waitcnt lgkmcnt(11)
    v_mfma_f32_32x32x16_bf16 v[64:79], v[128:131], v[136:139], v[64:79]
    ds_read_b64_tr_b16 v[170:171], v29 offset:37376
    ds_read_b64_tr_b16 v[172:173], v29 offset:45056
    s_waitcnt lgkmcnt(11)
    v_mfma_f32_32x32x16_bf16 v[96:111], v[128:131], v[140:143], v[96:111]
    ds_read_b64_tr_b16 v[174:175], v29 offset:45568
    s_waitcnt lgkmcnt(11)
    v_mfma_f32_32x32x16_bf16 v[80:95], v[132:135], v[136:139], v[80:95]
    ds_read_b128 v[164:167], v22 offset:20480
    v_mfma_f32_32x32x16_bf16 v[112:127], v[132:135], v[140:143], v[112:127]
    ds_read_b128 v[176:179], v23 offset:16384
    s_waitcnt lgkmcnt(10)
    v_mfma_f32_32x32x16_bf16 v[64:79], v[144:147], v[152:155], v[64:79]
    ds_read_b64_tr_b16 v[184:185], v29 offset:38912
    ds_read_b64_tr_b16 v[186:187], v29 offset:39424
    s_waitcnt lgkmcnt(10)
    v_mfma_f32_32x32x16_bf16 v[96:111], v[144:147], v[156:159], v[96:111]
    ds_read_b64_tr_b16 v[188:189], v29 offset:47104
    s_waitcnt lgkmcnt(10)
    v_mfma_f32_32x32x16_bf16 v[80:95], v[148:151], v[152:155], v[80:95]
    ds_read_b64_tr_b16 v[190:191], v29 offset:47616
    ds_read_b128 v[180:183], v23 offset:20480
    v_mfma_f32_32x32x16_bf16 v[112:127], v[148:151], v[156:159], v[112:127]
    s_waitcnt lgkmcnt(9)
    v_mfma_f32_32x32x16_bf16 v[64:79], v[160:163], v[168:171], v[64:79]
    s_waitcnt lgkmcnt(7)
    v_mfma_f32_32x32x16_bf16 v[96:111], v[160:163], v[172:175], v[96:111]
    s_waitcnt lgkmcnt(0)
    s_barrier
    ds_read_b128 v[128:131], v20 offset:32768
    ds_read_b64_tr_b16 v[136:137], v29 offset:0
    v_mfma_f32_32x32x16_bf16 v[80:95], v[164:167], v[168:171], v[80:95]
    ds_read_b64_tr_b16 v[138:139], v29 offset:512
    ds_read_b64_tr_b16 v[140:141], v29 offset:8192
    ds_read_b64_tr_b16 v[142:143], v29 offset:8704
    v_mfma_f32_32x32x16_bf16 v[112:127], v[164:167], v[172:175], v[112:127]
    ds_read_b128 v[132:135], v20 offset:36864
    ds_read_b128 v[144:147], v21 offset:32768
    v_mfma_f32_32x32x16_bf16 v[64:79], v[176:179], v[184:187], v[64:79]
    ds_read_b64_tr_b16 v[152:153], v29 offset:2048
    ds_read_b64_tr_b16 v[154:155], v29 offset:2560
    ds_read_b64_tr_b16 v[156:157], v29 offset:10240
    v_mfma_f32_32x32x16_bf16 v[96:111], v[176:179], v[188:191], v[96:111]
    ds_read_b64_tr_b16 v[158:159], v29 offset:10752
    ds_read_b128 v[148:151], v21 offset:36864
    v_mfma_f32_32x32x16_bf16 v[80:95], v[180:183], v[184:187], v[80:95]
    v_mfma_f32_32x32x16_bf16 v[112:127], v[180:183], v[188:191], v[112:127]
    ds_read_b128 v[160:163], v22 offset:32768
    ds_read_b64_tr_b16 v[168:169], v29 offset:4096
    s_waitcnt lgkmcnt(11)
    v_mfma_f32_32x32x16_bf16 v[64:79], v[128:131], v[136:139], v[64:79]
    ds_read_b64_tr_b16 v[170:171], v29 offset:4608
    ds_read_b64_tr_b16 v[172:173], v29 offset:12288
    s_waitcnt lgkmcnt(11)
    v_mfma_f32_32x32x16_bf16 v[96:111], v[128:131], v[140:143], v[96:111]
    ds_read_b64_tr_b16 v[174:175], v29 offset:12800
    s_waitcnt lgkmcnt(11)
    v_mfma_f32_32x32x16_bf16 v[80:95], v[132:135], v[136:139], v[80:95]
    ds_read_b128 v[164:167], v22 offset:36864
    v_mfma_f32_32x32x16_bf16 v[112:127], v[132:135], v[140:143], v[112:127]
    ds_read_b128 v[176:179], v23 offset:32768
    s_waitcnt lgkmcnt(10)
    v_mfma_f32_32x32x16_bf16 v[64:79], v[144:147], v[152:155], v[64:79]
    ds_read_b64_tr_b16 v[184:185], v29 offset:6144
    ds_read_b64_tr_b16 v[186:187], v29 offset:6656
    s_waitcnt lgkmcnt(10)
    v_mfma_f32_32x32x16_bf16 v[96:111], v[144:147], v[156:159], v[96:111]
    ds_read_b64_tr_b16 v[188:189], v29 offset:14336
    s_waitcnt lgkmcnt(10)
    v_mfma_f32_32x32x16_bf16 v[80:95], v[148:151], v[152:155], v[80:95]
    ds_read_b64_tr_b16 v[190:191], v29 offset:14848
    ds_read_b128 v[180:183], v23 offset:36864
    v_mfma_f32_32x32x16_bf16 v[112:127], v[148:151], v[156:159], v[112:127]
    s_waitcnt lgkmcnt(9)
    v_mfma_f32_32x32x16_bf16 v[64:79], v[160:163], v[168:171], v[64:79]
    s_waitcnt lgkmcnt(7)
    v_mfma_f32_32x32x16_bf16 v[96:111], v[160:163], v[172:175], v[96:111]
    s_waitcnt lgkmcnt(0)
    s_barrier
    ds_read_b128 v[128:131], v24 offset:0
    ds_read_b64_tr_b16 v[136:137], v29 offset:32768
    v_mfma_f32_32x32x16_bf16 v[80:95], v[164:167], v[168:171], v[80:95]
    ds_read_b64_tr_b16 v[138:139], v29 offset:33280
    ds_read_b64_tr_b16 v[140:141], v29 offset:40960
    ds_read_b64_tr_b16 v[142:143], v29 offset:41472
    v_mfma_f32_32x32x16_bf16 v[112:127], v[164:167], v[172:175], v[112:127]
    ds_read_b128 v[132:135], v24 offset:4096
    ds_read_b128 v[144:147], v25 offset:0
    v_mfma_f32_32x32x16_bf16 v[64:79], v[176:179], v[184:187], v[64:79]
    ds_read_b64_tr_b16 v[152:153], v29 offset:34816
    ds_read_b64_tr_b16 v[154:155], v29 offset:35328
    ds_read_b64_tr_b16 v[156:157], v29 offset:43008
    v_mfma_f32_32x32x16_bf16 v[96:111], v[176:179], v[188:191], v[96:111]
    ds_read_b64_tr_b16 v[158:159], v29 offset:43520
    ds_read_b128 v[148:151], v25 offset:4096
    v_mfma_f32_32x32x16_bf16 v[80:95], v[180:183], v[184:187], v[80:95]
    v_mfma_f32_32x32x16_bf16 v[112:127], v[180:183], v[188:191], v[112:127]
    ds_read_b128 v[160:163], v26 offset:0
    ds_read_b64_tr_b16 v[168:169], v29 offset:36864
    s_waitcnt lgkmcnt(11)
    v_mfma_f32_32x32x16_bf16 v[64:79], v[128:131], v[136:139], v[64:79]
    ds_read_b64_tr_b16 v[170:171], v29 offset:37376
    ds_read_b64_tr_b16 v[172:173], v29 offset:45056
    s_waitcnt lgkmcnt(11)
    v_mfma_f32_32x32x16_bf16 v[96:111], v[128:131], v[140:143], v[96:111]
    ds_read_b64_tr_b16 v[174:175], v29 offset:45568
    s_waitcnt lgkmcnt(11)
    v_mfma_f32_32x32x16_bf16 v[80:95], v[132:135], v[136:139], v[80:95]
    ds_read_b128 v[164:167], v26 offset:4096
    v_mfma_f32_32x32x16_bf16 v[112:127], v[132:135], v[140:143], v[112:127]
    ds_read_b128 v[176:179], v27 offset:0
    s_waitcnt lgkmcnt(10)
    v_mfma_f32_32x32x16_bf16 v[64:79], v[144:147], v[152:155], v[64:79]
    ds_read_b64_tr_b16 v[184:185], v29 offset:38912
    ds_read_b64_tr_b16 v[186:187], v29 offset:39424
    s_waitcnt lgkmcnt(10)
    v_mfma_f32_32x32x16_bf16 v[96:111], v[144:147], v[156:159], v[96:111]
    ds_read_b64_tr_b16 v[188:189], v29 offset:47104
    s_waitcnt lgkmcnt(10)
    v_mfma_f32_32x32x16_bf16 v[80:95], v[148:151], v[152:155], v[80:95]
    ds_read_b64_tr_b16 v[190:191], v29 offset:47616
    ds_read_b128 v[180:183], v27 offset:4096
    v_mfma_f32_32x32x16_bf16 v[112:127], v[148:151], v[156:159], v[112:127]
    s_waitcnt lgkmcnt(9)
    v_mfma_f32_32x32x16_bf16 v[64:79], v[160:163], v[168:171], v[64:79]
    s_waitcnt lgkmcnt(7)
    v_mfma_f32_32x32x16_bf16 v[96:111], v[160:163], v[172:175], v[96:111]
    s_waitcnt lgkmcnt(0)
    s_barrier
    s_add_u32 s12, s46, 2
    s_and_b32 s12, s12, 7
    s_mul_i32 s11, s12, 196608
    s_add_u32 s11, s11, s9
    s_add_u32 m0, s7, 147456
    s_add_u32 s10, s11, 0
    buffer_load_dwordx4 v9, s[56:59], s10 offen lds
    s_add_u32 m0, s7, 148480
    s_add_u32 s10, s11, 24576
    buffer_load_dwordx4 v9, s[56:59], s10 offen lds
    s_add_u32 s12, s46, 3
    s_and_b32 s12, s12, 7
    s_mul_i32 s11, s12, 196608
    s_add_u32 s11, s11, s9
    s_add_u32 m0, s7, 155648
    s_add_u32 s10, s11, 0
    buffer_load_dwordx4 v9, s[56:59], s10 offen lds
    s_add_u32 m0, s7, 156672
    s_add_u32 s10, s11, 24576
    buffer_load_dwordx4 v9, s[56:59], s10 offen lds
    v_mfma_f32_32x32x16_bf16 v[80:95], v[164:167], v[168:171], v[80:95]
    v_mfma_f32_32x32x16_bf16 v[112:127], v[164:167], v[172:175], v[112:127]
    v_mfma_f32_32x32x16_bf16 v[64:79], v[176:179], v[184:187], v[64:79]
    v_mfma_f32_32x32x16_bf16 v[96:111], v[176:179], v[188:191], v[96:111]
    v_mfma_f32_32x32x16_bf16 v[80:95], v[180:183], v[184:187], v[80:95]
    v_mfma_f32_32x32x16_bf16 v[112:127], v[180:183], v[188:191], v[112:127]
    v_mov_b32 v248, 0x3f803f80
    v_mov_b32 v249, 0x3f803f80
    v_mov_b32 v250, 0x3f803f80
    v_mov_b32 v251, 0x3f803f80
    s_barrier
    s_nop 3
    v_mul_f32 v128, s64, v64
    v_mul_f32 v129, s64, v65
    v_mul_f32 v130, s64, v66
    v_mul_f32 v131, s64, v67
    v_mul_f32 v132, s64, v68
    v_mul_f32 v133, s64, v69
    v_mul_f32 v134, s64, v70
    v_mul_f32 v135, s64, v71
    v_mul_f32 v136, s64, v72
    v_mul_f32 v137, s64, v73
    v_mul_f32 v138, s64, v74
    v_mul_f32 v139, s64, v75
    v_mul_f32 v140, s64, v76
    v_mul_f32 v141, s64, v77
    v_mul_f32 v142, s64, v78
    v_mul_f32 v143, s64, v79
    v_exp_f32 v128, v128 clamp
    v_max_f32 v64, s66, v64
    v_exp_f32 v129, v129 clamp
    v_max_f32 v65, s66, v65
    v_exp_f32 v130, v130 clamp
    v_max_f32 v66, s66, v66
    v_exp_f32 v131, v131 clamp
    v_max_f32 v67, s66, v67
    v_exp_f32 v132, v132 clamp
    s_waitcnt vmcnt(0)
    s_barrier
    s_add_u32 s12, s46, 4
    s_and_b32 s12, s12, 7
    s_mul_i32 s11, s12, 196608
    s_add_u32 s11, s11, s9
    s_add_u32 m0, s7, 114688
    s_add_u32 s10, s11, 0
    buffer_load_dwordx4 v9, s[56:59], s10 offen lds
    s_add_u32 m0, s7, 115712
    s_add_u32 s10, s11, 24576
    buffer_load_dwordx4 v9, s[56:59], s10 offen lds
    s_add_u32 s12, s46, 5
    s_and_b32 s12, s12, 7
    s_mul_i32 s11, s12, 196608
    s_add_u32 s11, s11, s9
    s_add_u32 m0, s7, 0
    s_add_u32 s10, s11, 0
    buffer_load_dwordx4 v9, s[56:59], s10 offen lds
    s_add_u32 m0, s7, 1024
    s_add_u32 s10, s11, 24576
    buffer_load_dwordx4 v9, s[56:59], s10 offen lds
    s_add_u32 s12, s46, 6
    s_and_b32 s12, s12, 7
    s_mul_i32 s11, s12, 196608
    s_add_u32 s11, s11, s9
    s_add_u32 m0, s7, 8192
    s_add_u32 s10, s11, 0
    buffer_load_dwordx4 v9, s[56:59], s10 offen lds
    s_add_u32 m0, s7, 9216
    s_add_u32 s10, s11, 24576
    buffer_load_dwordx4 v9, s[56:59], s10 offen lds
    v_max_f32 v68, s66, v68
    v_exp_f32 v133, v133 clamp
    v_max_f32 v69, s66, v69
    v_exp_f32 v134, v134 clamp
    v_max_f32 v70, s66, v70
    v_exp_f32 v135, v135 clamp
    v_max_f32 v71, s66, v71
    v_exp_f32 v136, v136 clamp
    v_max_f32 v72, s66, v72
    v_exp_f32 v137, v137 clamp
    v_max_f32 v73, s66, v73
    v_exp_f32 v138, v138 clamp
    v_max_f32 v74, s66, v74
    v_exp_f32 v139, v139 clamp
    v_max_f32 v75, s66, v75
    v_exp_f32 v140, v140 clamp
    v_max_f32 v76, s66, v76
    v_exp_f32 v141, v141 clamp
    v_max_f32 v77, s66, v77
    v_exp_f32 v142, v142 clamp
    v_max_f32 v78, s66, v78
    v_exp_f32 v143, v143 clamp
    v_max_f32 v79, s66, v79
    v_add_f32 v64, v64, v128
    v_add_f32 v65, v65, v129
    v_add_f32 v66, v66, v130
    v_add_f32 v67, v67, v131
    v_add_f32 v68, v68, v132
    v_add_f32 v69, v69, v133
    v_add_f32 v70, v70, v134
    v_add_f32 v71, v71, v135
    v_add_f32 v72, v72, v136
    v_add_f32 v73, v73, v137
    v_add_f32 v74, v74, v138
    v_add_f32 v75, v75, v139
    v_add_f32 v76, v76, v140
    v_add_f32 v77, v77, v141
    v_add_f32 v78, v78, v142
    v_add_f32 v79, v79, v143
    v_cvt_pk_bf16_f32 v32, v64, v65
    v_cvt_pk_bf16_f32 v33, v66, v67
    v_cvt_pk_bf16_f32 v34, v68, v69
    v_cvt_pk_bf16_f32 v35, v70, v71
    v_cvt_pk_bf16_f32 v36, v72, v73
    v_cvt_pk_bf16_f32 v37, v74, v75
    v_cvt_pk_bf16_f32 v38, v76, v77
    v_cvt_pk_bf16_f32 v39, v78, v79
    v_cvt_pk_bf16_f32 v48, v96, v97
    v_cvt_pk_bf16_f32 v49, v98, v99
    v_cvt_pk_bf16_f32 v50, v100, v101
    v_cvt_pk_bf16_f32 v51, v102, v103
    v_cvt_pk_bf16_f32 v52, v104, v105
    v_cvt_pk_bf16_f32 v53, v106, v107
    v_cvt_pk_bf16_f32 v54, v108, v109
    v_cvt_pk_bf16_f32 v55, v110, v111
    v_mfma_f32_32x32x16_bf16 v[144:159], v[32:35], v[48:51], 0
    v_mfma_f32_32x32x16_bf16 v[160:175], v[32:35], v[248:251], 0
    v_mfma_f32_32x32x16_bf16 v[144:159], v[36:39], v[52:55], v[144:159]
    v_mfma_f32_32x32x16_bf16 v[160:175], v[36:39], v[248:251], v[160:175]
    v_mul_f32 v128, s64, v80
    v_mul_f32 v129, s64, v81
    v_mul_f32 v130, s64, v82
    v_mul_f32 v131, s64, v83
    v_mul_f32 v132, s64, v84
    v_mul_f32 v133, s64, v85
    v_mul_f32 v134, s64, v86
    v_mul_f32 v135, s64, v87
    v_mul_f32 v136, s64, v88
    v_mul_f32 v137, s64, v89
    v_mul_f32 v138, s64, v90
    v_mul_f32 v139, s64, v91
    v_mul_f32 v140, s64, v92
    v_mul_f32 v141, s64, v93
    v_mul_f32 v142, s64, v94
    v_mul_f32 v143, s64, v95
    v_exp_f32 v128, v128 clamp
    v_max_f32 v80, s66, v80
    v_exp_f32 v129, v129 clamp
    v_max_f32 v81, s66, v81
    v_exp_f32 v130, v130 clamp
    v_max_f32 v82, s66, v82
    v_exp_f32 v131, v131 clamp
    v_max_f32 v83, s66, v83
    v_exp_f32 v132, v132 clamp
    v_max_f32 v84, s66, v84
    v_exp_f32 v133, v133 clamp
    v_max_f32 v85, s66, v85
    v_exp_f32 v134, v134 clamp
    v_max_f32 v86, s66, v86
    v_exp_f32 v135, v135 clamp
    s_waitcnt vmcnt(0)
    s_barrier
    s_add_u32 s12, s46, 7
    s_and_b32 s12, s12, 7
    s_mul_i32 s11, s12, 196608
    s_add_u32 s11, s11, s9
    s_add_u32 m0, s7, 122880
    s_add_u32 s10, s11, 0
    buffer_load_dwordx4 v9, s[56:59], s10 offen lds
    s_add_u32 m0, s7, 123904
    s_add_u32 s10, s11, 24576
    buffer_load_dwordx4 v9, s[56:59], s10 offen lds
    v_max_f32 v87, s66, v87
    v_exp_f32 v136, v136 clamp
    v_max_f32 v88, s66, v88
    v_exp_f32 v137, v137 clamp
    v_max_f32 v89, s66, v89
    v_exp_f32 v138, v138 clamp
    v_max_f32 v90, s66, v90
    v_exp_f32 v139, v139 clamp
    v_max_f32 v91, s66, v91
    v_exp_f32 v140, v140 clamp
    v_max_f32 v92, s66, v92
    v_exp_f32 v141, v141 clamp
    v_max_f32 v93, s66, v93
    v_exp_f32 v142, v142 clamp
    v_max_f32 v94, s66, v94
    v_exp_f32 v143, v143 clamp
    v_max_f32 v95, s66, v95
    v_add_f32 v80, v80, v128
    v_add_f32 v81, v81, v129
    v_add_f32 v82, v82, v130
    v_add_f32 v83, v83, v131
    v_add_f32 v84, v84, v132
    v_add_f32 v85, v85, v133
    v_add_f32 v86, v86, v134
    v_add_f32 v87, v87, v135
    v_add_f32 v88, v88, v136
    v_add_f32 v89, v89, v137
    v_add_f32 v90, v90, v138
    v_add_f32 v91, v91, v139
    v_add_f32 v92, v92, v140
    v_add_f32 v93, v93, v141
    v_add_f32 v94, v94, v142
    v_add_f32 v95, v95, v143
    v_cvt_pk_bf16_f32 v40, v80, v81
    v_cvt_pk_bf16_f32 v41, v82, v83
    v_cvt_pk_bf16_f32 v42, v84, v85
    v_cvt_pk_bf16_f32 v43, v86, v87
    v_cvt_pk_bf16_f32 v44, v88, v89
    v_cvt_pk_bf16_f32 v45, v90, v91
    v_cvt_pk_bf16_f32 v46, v92, v93
    v_cvt_pk_bf16_f32 v47, v94, v95
    v_cvt_pk_bf16_f32 v56, v112, v113
    v_cvt_pk_bf16_f32 v57, v114, v115
    v_cvt_pk_bf16_f32 v58, v116, v117
    v_cvt_pk_bf16_f32 v59, v118, v119
    v_cvt_pk_bf16_f32 v60, v120, v121
    v_cvt_pk_bf16_f32 v61, v122, v123
    v_cvt_pk_bf16_f32 v62, v124, v125
    v_cvt_pk_bf16_f32 v63, v126, v127
    v_mfma_f32_32x32x16_bf16 v[144:159], v[40:43], v[56:59], v[144:159]
    v_mfma_f32_32x32x16_bf16 v[160:175], v[40:43], v[248:251], v[160:175]
    v_mfma_f32_32x32x16_bf16 v[144:159], v[44:47], v[60:63], v[144:159]
    v_mfma_f32_32x32x16_bf16 v[160:175], v[44:47], v[248:251], v[160:175]
A_poll:
    v_readfirstlane_b32 s12, v4
    s_nop 0
    s_cmp_lg_u32 s12, 0
    s_nop 8
    s_cbranch_scc1 A_polled
    s_sleep 2
    global_load_dword v4, v5, s[40:41] sc0 sc1
    s_waitcnt vmcnt(0)
    s_branch A_poll
A_polled:
    v_cndmask_b32 v64, v144, v152, s[68:69]
    v_cndmask_b32 v65, v145, v153, s[68:69]
    v_cndmask_b32 v66, v146, v154, s[68:69]
    v_cndmask_b32 v67, v147, v155, s[68:69]
    v_cndmask_b32 v68, v148, v156, s[68:69]
    v_cndmask_b32 v69, v149, v157, s[68:69]
    v_cndmask_b32 v70, v150, v158, s[68:69]
    v_cndmask_b32 v71, v151, v159, s[68:69]
    ds_write_b128 v30, v[64:67] offset:0
    ds_write_b128 v30, v[68:71] offset:256
    v_cndmask_b32 v72, v160, v168, s[68:69]
    v_cndmask_b32 v73, v161, v169, s[68:69]
    v_cndmask_b32 v74, v162, v170, s[68:69]
    v_cndmask_b32 v75, v163, v171, s[68:69]
    v_cndmask_b32 v76, v164, v172, s[68:69]
    v_cndmask_b32 v77, v165, v173, s[68:69]
    v_cndmask_b32 v78, v166, v174, s[68:69]
    v_cndmask_b32 v79, v167, v175, s[68:69]
    s_mov_b32 exec_lo, 0x00010001
    s_mov_b32 exec_hi, 0x00010001
    ds_write_b128 v31, v[72:75] offset:4096
    ds_write_b128 v31, v[76:79] offset:4112
    s_mov_b64 exec, -1
    s_waitcnt vmcnt(0) lgkmcnt(0)
    s_barrier
    ds_read_b32 v32, v8 offset:0
    ds_read_b32 v33, v8 offset:4352
    ds_read_b32 v34, v8 offset:1024
    ds_read_b32 v35, v8 offset:5376
    ds_read_b32 v36, v8 offset:2048
    ds_read_b32 v37, v8 offset:6400
    ds_read_b32 v38, v8 offset:3072
    ds_read_b32 v39, v8 offset:7424
    ds_read_b32 v40, v8 offset:4096
    ds_read_b32 v41, v8 offset:8448
    s_waitcnt lgkmcnt(8)
    v_add_f32 v32, v32, v33
    buffer_atomic_add_f32 v32, v6, s[60:63], 0 offen offset:0
    s_waitcnt lgkmcnt(6)
    v_add_f32 v34, v34, v35
    buffer_atomic_add_f32 v34, v6, s[60:63], 0 offen offset:1024
    s_waitcnt lgkmcnt(4)
    v_add_f32 v36, v36, v37
    buffer_atomic_add_f32 v36, v6, s[60:63], 0 offen offset:2048
    s_waitcnt lgkmcnt(2)
    v_add_f32 v38, v38, v39
    buffer_atomic_add_f32 v38, v6, s[60:63], 0 offen offset:3072
    s_waitcnt lgkmcnt(0)
    v_add_f32 v40, v40, v41
    buffer_atomic_add_f32 v40, v7, s[60:63], 0 offen
    s_cmp_eq_u32 s49, 0
    s_cbranch_scc0 A_gdone
    v_lshrrev_b32 v10, 4, v1
    v_lshlrev_b32 v10, 4, v10
    v_add_u32 v11, 65536, v10
    ds_read_b128 v[48:51], v11 offset:8704
    ds_read_b128 v[52:55], v11 offset:8768
    s_waitcnt lgkmcnt(0)
    v_add_f32 v48, v48, v52
    v_add_f32 v49, v49, v53
    v_add_f32 v50, v50, v54
    v_add_f32 v51, v51, v55
    v_cvt_pk_bf16_f32 v52, v48, v49
    v_cvt_pk_bf16_f32 v53, v50, v51
    v_lshlrev_b32 v48, 16, v52
    v_and_b32 v49, 0xffff0000, v52
    v_lshlrev_b32 v50, 16, v53
    v_and_b32 v51, 0xffff0000, v53
    v_mul_f32 v48, 0xbfb8aa3b, v48
    v_mul_f32 v49, 0xbfb8aa3b, v49
    v_mul_f32 v50, 0xbfb8aa3b, v50
    v_mul_f32 v51, 0xbfb8aa3b, v51
    v_exp_f32 v48, v48
    v_exp_f32 v49, v49
    v_exp_f32 v50, v50
    v_exp_f32 v51, v51
    v_add_f32 v48, 1.0, v48
    v_add_f32 v49, 1.0, v49
    v_add_f32 v50, 1.0, v50
    v_add_f32 v51, 1.0, v51
    v_rcp_f32 v48, v48
    v_rcp_f32 v49, v49
    v_rcp_f32 v50, v50
    v_rcp_f32 v51, v51
    v_cvt_pk_bf16_f32 v52, v48, v49
    v_cvt_pk_bf16_f32 v53, v50, v51
    v_lshlrev_b32 v48, 16, v52
    v_and_b32 v49, 0xffff0000, v52
    v_lshlrev_b32 v50, 16, v53
    v_and_b32 v51, 0xffff0000, v53
    s_lshl_b32 s47, s44, 9
    s_lshl_b32 s48, s45, 6
    s_add_u32 s47, s47, s48
    s_add_u32 s47, s47, 4259840
    v_add_u32 v10, s47, v10
    global_store_dwordx4 v10, v[48:51], s[42:43] sc0 sc1
    s_nop 1
A_gdone:
    s_endpgm
B_rest:
    v_and_b32 v26, -2, v26
    v_lshlrev_b32 v148, 1, v26
    v_add_u32 v148, 116608, v148
    v_xor_b32 v149, 4, v148
    v_and_b32 v25, 1, v25
    v_mul_u32_u24 v25, 0x040404, v25
    v_lshl_or_b32 v25, v25, 8, v25
    v_xor_b32 v154, 0x05040100, v25
    v_xor_b32 v155, 0x07060302, v25
    v_and_b32 v2, 15, v1
    v_lshrrev_b32 v3, 4, v1
    s_mul_i32 s49, s44, 4608
    s_add_u32 s49, s49, 116096
    s_mul_i32 s50, s44, 3200
    s_add_u32 s50, s50, 134528
    s_mov_b32 s52, 0x3fb8aa3b
    s_mov_b32 s53, 0x32a57060
    s_mov_b32 s54, 0x3f317218
    v_mov_b32 v24, 0
    v_mov_b32 v25, 0
    v_mov_b32 v26, 0
    v_mov_b32 v27, 0
    v_lshrrev_b32 v22, 7, v0
    v_mul_u32_u24 v22, 4608, v22
    v_and_b32 v23, 127, v0
    v_lshl_add_u32 v22, v23, 2, v22
    v_add_u32 v22, 116096, v22
    ds_write_b32 v22, v24
    v_lshlrev_b32 v22, 4, v0
    v_add_u32 v22, 134528, v22
    ds_write_b128 v22, v[24:27]
    v_min_u32 v22, 139120, v22
    ds_write_b128 v22, v[24:27] offset:8192
    v_lshlrev_b32 v23, 2, v23
    v_add_u32 v23, 115584, v23
    v_mov_b32 v28, 0x3f80
    ds_write_b32 v23, v28
    v_lshrrev_b32 v22, 6, v0
    v_lshlrev_b32 v23, 2, v22
    s_mov_b32 s48, 0x00531234
    v_bfe_u32 v28, s48, v23, 4
    s_mov_b32 s48, 0x00239753
    v_bfe_u32 v29, s48, v23, 4
    v_subrev_u32 v30, 28, v1
    v_sub_u32 v30, v30, v28
    v_mov_b32 v28, 0x3f80
    v_mov_b32 v31, 0xffff
    v_cmp_lt_u32 vcc, 3, v22
    s_nop 1
    v_cndmask_b32 v28, v28, v31, vcc
    v_cmp_lt_u32 vcc, v30, v29
    s_nop 1
    v_cndmask_b32 v28, 0, v28, vcc
    v_lshlrev_b32 v22, 1, v0
    v_add_u32 v22, 147328, v22
    ds_write_b16 v22, v28
    ds_write_b16 v22, v28 offset:1214
    s_lshl_b32 s56, s44, 9
    s_lshl_b32 s48, s45, 8
    s_add_u32 s56, s56, s48
    s_add_u32 s57, s56, 57792
    v_lshrrev_b32 v22, 1, v3
    v_lshlrev_b32 v22, 7, v22
    v_and_b32 v23, 1, v3
    v_lshl_add_u32 v22, v23, 8, v22
    s_lshl_b32 s48, s44, 9
    v_add_u32 v23, s48, v22
    v_mul_u32_u24 v24, 2064, v2
    v_add_u32 v130, v23, v24
    s_cmp_eq_u32 s45, 0
    s_cselect_b32 s48, 82560, s48
    s_mov_b32 s6, 30960
    s_cselect_b32 s48, s48, s6
    v_add_u32 v131, s48, v130
    v_add_u32 v25, 115584, v22
    v_sub_u32 v26, v2, s45
    v_cmp_eq_u32 vcc, -1, v26
    s_nop 1
    v_cndmask_b32 v131, v131, v25, vcc
    s_mov_b32 s58, 0x43222100
    s_mov_b32 s59, 0x87666544
    v_lshlrev_b32 v25, 2, v2
    v_lshrrev_b64 v[26:27], v25, s[58:59]
    v_and_b32 v26, 15, v26
    v_add_u32 v26, 31, v26
    v_mul_u32_u24 v26, 2064, v26
    v_add_u32 v132, v23, v26
    v_and_b32 v22, 1, v2
    v_xor_b32 v22, 1, v22
    v_mul_u32_u24 v23, 1214, v22
    v_lshl_add_u32 v23, v3, 4, v23
    v_lshlrev_b32 v24, 1, v2
    v_sub_u32 v6, v23, v24
    v_add_u32 v11, 147330, v6
    s_waitcnt lgkmcnt(0)
    s_barrier
    s_cmp_eq_u32 s45, 0
    s_cbranch_scc0 B_nopat
    ds_read2_b32 v[172:173], v11 offset0:10 offset1:11
    ds_read2_b32 v[174:175], v11 offset0:12 offset1:13
    ds_read2_b32 v[176:177], v11 offset0:44 offset1:45
    ds_read2_b32 v[178:179], v11 offset0:46 offset1:47
    ds_read2_b32 v[180:181], v11 offset0:14 offset1:15
    ds_read2_b32 v[182:183], v11 offset0:16 offset1:17
    ds_read2_b32 v[184:185], v11 offset0:44 offset1:45
    ds_read2_b32 v[186:187], v11 offset0:46 offset1:47
    s_waitcnt lgkmcnt(4)
    ds_read2_b32 v[188:189], v11 offset0:76 offset1:77
    ds_read2_b32 v[190:191], v11 offset0:78 offset1:79
    ds_read2_b32 v[192:193], v11 offset0:108 offset1:109
    ds_read2_b32 v[194:195], v11 offset0:110 offset1:111
    ds_read2_b32 v[196:197], v11 offset0:136 offset1:137
    ds_read2_b32 v[198:199], v11 offset0:138 offset1:139
    ds_read2_b32 v[200:201], v11 offset0:170 offset1:171
    ds_read2_b32 v[202:203], v11 offset0:172 offset1:173
    s_waitcnt lgkmcnt(0)
B_nopat:
    s_waitcnt vmcnt(1)
    v_lshlrev_b32 v20, 16, v20
    v_lshlrev_b32 v16, 16, v16
    v_lshlrev_b32 v17, 16, v17
    v_lshlrev_b32 v18, 16, v18
    v_lshlrev_b32 v19, 16, v19
    v_lshlrev_b32 v21, 16, v21
    v_mul_f32 v22, s52, v20
    v_fma_f32 v23, v20, s52, -v22
    v_fma_f32 v23, v20, s53, v23
    v_exp_f32 v22, v22
    v_mul_f32 v23, s54, v23
    v_fma_f32 v22, v22, v23, v22
    v_cvt_pk_bf16_f32 v22, v22, v22
    v_lshlrev_b32 v20, 16, v22
    v_mul_f32 v24, s52, v16
    v_fma_f32 v25, v16, s52, -v24
    v_fma_f32 v25, v16, s53, v25
    v_exp_f32 v24, v24
    v_mul_f32 v25, s54, v25
    v_fma_f32 v24, v24, v25, v24
    v_cvt_pk_bf16_f32 v24, v24, v24
    v_lshlrev_b32 v16, 16, v24
    v_mul_f32 v16, v16, v20
    v_mul_f32 v17, v17, v20
    v_mul_f32 v16, 0xbfb8aa3b, v16
    v_mul_f32 v17, 0x3e22f983, v17
    v_add_f32 v20, v20, v20
    v_mul_f32 v80, v18, v20
    v_mul_f32 v81, v19, v20
    v_exp_f32 v22, v16
    v_fract_f32 v23, v17
    v_cos_f32 v32, v23
    v_sin_f32 v33, v23
    s_nop 0
    v_pk_mul_f32 v[32:33], v[32:33], v[22:23] op_sel_hi:[1,0]
    v_mul_f32 v24, 0x41800000, v16
    v_mul_f32 v25, 0x41800000, v17
    v_exp_f32 v24, v24
    v_fract_f32 v25, v25
    v_cos_f32 v62, v25
    v_sin_f32 v63, v25
    s_nop 0
    v_pk_mul_f32 v[62:63], v[62:63], v[24:25] op_sel_hi:[1,0]
    v_mul_f32 v26, 0x43800000, v16
    v_mul_f32 v27, 0x43800000, v17
    v_exp_f32 v26, v26
    v_fract_f32 v27, v27
    v_cos_f32 v64, v27
    v_sin_f32 v65, v27
    s_nop 0
    v_pk_mul_f32 v[64:65], v[64:65], v[26:27] op_sel_hi:[1,0]
    v_pk_mul_f32 v[34:35], v[32:33], v[32:33] op_sel_hi:[1,0]
    v_pk_fma_f32 v[34:35], v[32:33], v[32:33], v[34:35] op_sel:[1,1,0] op_sel_hi:[0,1,1] neg_lo:[1,0,0]
    s_mov_b32 m0, s56
    v_cvt_pk_bf16_f32 v126, v32, v33
    ds_write_addtid_b32 v126 offset:33024
    v_pk_mul_f32 v[112:113], v[62:63], v[62:63] op_sel_hi:[1,0]
    v_pk_fma_f32 v[112:113], v[62:63], v[62:63], v[112:113] op_sel:[1,1,0] op_sel_hi:[0,1,1] neg_lo:[1,0,0]
    v_cvt_pk_bf16_f32 v127, v80, -v81
    ds_write_addtid_b32 v127 offset:0
    v_pk_mul_f32 v[82:83], v[80:81], v[62:63] op_sel_hi:[1,0]
    v_pk_fma_f32 v[82:83], v[80:81], v[62:63], v[82:83] op_sel:[1,1,0] op_sel_hi:[0,1,1] neg_lo:[1,0,0]
    v_pk_mul_f32 v[66:67], v[64:65], v[64:65] op_sel_hi:[1,0]
    v_pk_fma_f32 v[66:67], v[64:65], v[64:65], v[66:67] op_sel:[1,1,0] op_sel_hi:[0,1,1] neg_lo:[1,0,0]
    v_pk_mul_f32 v[36:37], v[34:35], v[32:33] op_sel_hi:[1,0]
    v_pk_fma_f32 v[36:37], v[34:35], v[32:33], v[36:37] op_sel:[1,1,0] op_sel_hi:[0,1,1] neg_lo:[1,0,0]
    v_cvt_pk_bf16_f32 v128, v34, v35
    ds_write_addtid_b32 v128 offset:35088
    v_pk_mul_f32 v[38:39], v[34:35], v[34:35] op_sel_hi:[1,0]
    v_pk_fma_f32 v[38:39], v[34:35], v[34:35], v[38:39] op_sel:[1,1,0] op_sel_hi:[0,1,1] neg_lo:[1,0,0]
    v_cvt_pk_bf16_f32 v129, v82, -v83
    ds_write_addtid_b32 v129 offset:2064
    v_pk_mul_f32 v[114:115], v[112:113], v[112:113] op_sel_hi:[1,0]
    v_pk_fma_f32 v[114:115], v[112:113], v[112:113], v[114:115] op_sel:[1,1,0] op_sel_hi:[0,1,1] neg_lo:[1,0,0]
    v_pk_mul_f32 v[84:85], v[80:81], v[112:113] op_sel_hi:[1,0]
    v_pk_fma_f32 v[84:85], v[80:81], v[112:113], v[84:85] op_sel:[1,1,0] op_sel_hi:[0,1,1] neg_lo:[1,0,0]
    v_cvt_pk_bf16_f32 v126, v36, v37
    ds_write_addtid_b32 v126 offset:37152
    v_pk_mul_f32 v[86:87], v[82:83], v[112:113] op_sel_hi:[1,0]
    v_pk_fma_f32 v[86:87], v[82:83], v[112:113], v[86:87] op_sel:[1,1,0] op_sel_hi:[0,1,1] neg_lo:[1,0,0]
    v_cvt_pk_bf16_f32 v127, v38, v39
    ds_write_addtid_b32 v127 offset:39216
    v_pk_mul_f32 v[68:69], v[66:67], v[64:65] op_sel_hi:[1,0]
    v_pk_fma_f32 v[68:69], v[66:67], v[64:65], v[68:69] op_sel:[1,1,0] op_sel_hi:[0,1,1] neg_lo:[1,0,0]
    v_pk_mul_f32 v[70:71], v[66:67], v[66:67] op_sel_hi:[1,0]
    v_pk_fma_f32 v[70:71], v[66:67], v[66:67], v[70:71] op_sel:[1,1,0] op_sel_hi:[0,1,1] neg_lo:[1,0,0]
    v_pk_mul_f32 v[46:47], v[38:39], v[38:39] op_sel_hi:[1,0]
    v_pk_fma_f32 v[46:47], v[38:39], v[38:39], v[46:47] op_sel:[1,1,0] op_sel_hi:[0,1,1] neg_lo:[1,0,0]
    v_cvt_pk_bf16_f32 v128, v84, -v85
    ds_write_addtid_b32 v128 offset:4128
    v_pk_mul_f32 v[116:117], v[114:115], v[114:115] op_sel_hi:[1,0]
    v_pk_fma_f32 v[116:117], v[114:115], v[114:115], v[116:117] op_sel:[1,1,0] op_sel_hi:[0,1,1] neg_lo:[1,0,0]
    v_cvt_pk_bf16_f32 v129, v86, -v87
    ds_write_addtid_b32 v129 offset:6192
    v_pk_mul_f32 v[40:41], v[38:39], v[32:33] op_sel_hi:[1,0]
    v_pk_fma_f32 v[40:41], v[38:39], v[32:33], v[40:41] op_sel:[1,1,0] op_sel_hi:[0,1,1] neg_lo:[1,0,0]
    v_pk_mul_f32 v[42:43], v[38:39], v[34:35] op_sel_hi:[1,0]
    v_pk_fma_f32 v[42:43], v[38:39], v[34:35], v[42:43] op_sel:[1,1,0] op_sel_hi:[0,1,1] neg_lo:[1,0,0]
    v_pk_mul_f32 v[44:45], v[38:39], v[36:37] op_sel_hi:[1,0]
    v_pk_fma_f32 v[44:45], v[38:39], v[36:37], v[44:45] op_sel:[1,1,0] op_sel_hi:[0,1,1] neg_lo:[1,0,0]
    v_cvt_pk_bf16_f32 v126, v46, v47
    ds_write_addtid_b32 v126 offset:47472
    global_load_dwordx2 v[142:143], v151, s[16:17]
    v_pk_mul_f32 v[88:89], v[80:81], v[114:115] op_sel_hi:[1,0]
    v_pk_fma_f32 v[88:89], v[80:81], v[114:115], v[88:89] op_sel:[1,1,0] op_sel_hi:[0,1,1] neg_lo:[1,0,0]
    v_cvt_pk_bf16_f32 v127, v40, v41
    ds_write_addtid_b32 v127 offset:41280
    v_pk_mul_f32 v[90:91], v[82:83], v[114:115] op_sel_hi:[1,0]
    v_pk_fma_f32 v[90:91], v[82:83], v[114:115], v[90:91] op_sel:[1,1,0] op_sel_hi:[0,1,1] neg_lo:[1,0,0]
    v_cvt_pk_bf16_f32 v128, v42, v43
    ds_write_addtid_b32 v128 offset:43344
    v_pk_mul_f32 v[92:93], v[84:85], v[114:115] op_sel_hi:[1,0]
    v_pk_fma_f32 v[92:93], v[84:85], v[114:115], v[92:93] op_sel:[1,1,0] op_sel_hi:[0,1,1] neg_lo:[1,0,0]
    v_cvt_pk_bf16_f32 v129, v44, v45
    ds_write_addtid_b32 v129 offset:45408
    v_pk_mul_f32 v[94:95], v[86:87], v[114:115] op_sel_hi:[1,0]
    v_pk_fma_f32 v[94:95], v[86:87], v[114:115], v[94:95] op_sel:[1,1,0] op_sel_hi:[0,1,1] neg_lo:[1,0,0]
    v_pk_mul_f32 v[72:73], v[70:71], v[64:65] op_sel_hi:[1,0]
    v_pk_fma_f32 v[72:73], v[70:71], v[64:65], v[72:73] op_sel:[1,1,0] op_sel_hi:[0,1,1] neg_lo:[1,0,0]
    v_cvt_pk_bf16_f32 v126, v88, -v89
    ds_write_addtid_b32 v126 offset:8256
    v_pk_mul_f32 v[74:75], v[70:71], v[66:67] op_sel_hi:[1,0]
    v_pk_fma_f32 v[74:75], v[70:71], v[66:67], v[74:75] op_sel:[1,1,0] op_sel_hi:[0,1,1] neg_lo:[1,0,0]
    v_cvt_pk_bf16_f32 v127, v90, -v91
    ds_write_addtid_b32 v127 offset:10320
    v_pk_mul_f32 v[76:77], v[70:71], v[68:69] op_sel_hi:[1,0]
    v_pk_fma_f32 v[76:77], v[70:71], v[68:69], v[76:77] op_sel:[1,1,0] op_sel_hi:[0,1,1] neg_lo:[1,0,0]
    v_cvt_pk_bf16_f32 v128, v92, -v93
    ds_write_addtid_b32 v128 offset:12384
    v_cvt_pk_bf16_f32 v129, v94, -v95
    ds_write_addtid_b32 v129 offset:14448
    v_pk_mul_f32 v[96:97], v[80:81], v[116:117] op_sel_hi:[1,0]
    v_pk_fma_f32 v[96:97], v[80:81], v[116:117], v[96:97] op_sel:[1,1,0] op_sel_hi:[0,1,1] neg_lo:[1,0,0]
    v_pk_mul_f32 v[98:99], v[82:83], v[116:117] op_sel_hi:[1,0]
    v_pk_fma_f32 v[98:99], v[82:83], v[116:117], v[98:99] op_sel:[1,1,0] op_sel_hi:[0,1,1] neg_lo:[1,0,0]
    v_cvt_pk_bf16_f32 v126, v96, -v97
    ds_write_addtid_b32 v126 offset:16512
    v_pk_mul_f32 v[100:101], v[84:85], v[116:117] op_sel_hi:[1,0]
    v_pk_fma_f32 v[100:101], v[84:85], v[116:117], v[100:101] op_sel:[1,1,0] op_sel_hi:[0,1,1] neg_lo:[1,0,0]
    v_cvt_pk_bf16_f32 v127, v98, -v99
    ds_write_addtid_b32 v127 offset:18576
    v_pk_mul_f32 v[102:103], v[86:87], v[116:117] op_sel_hi:[1,0]
    v_pk_fma_f32 v[102:103], v[86:87], v[116:117], v[102:103] op_sel:[1,1,0] op_sel_hi:[0,1,1] neg_lo:[1,0,0]
    v_cvt_pk_bf16_f32 v128, v100, -v101
    ds_write_addtid_b32 v128 offset:20640
    v_pk_mul_f32 v[104:105], v[88:89], v[116:117] op_sel_hi:[1,0]
    v_pk_fma_f32 v[104:105], v[88:89], v[116:117], v[104:105] op_sel:[1,1,0] op_sel_hi:[0,1,1] neg_lo:[1,0,0]
    v_cvt_pk_bf16_f32 v129, v102, -v103
    ds_write_addtid_b32 v129 offset:22704
    v_pk_mul_f32 v[106:107], v[90:91], v[116:117] op_sel_hi:[1,0]
    v_pk_fma_f32 v[106:107], v[90:91], v[116:117], v[106:107] op_sel:[1,1,0] op_sel_hi:[0,1,1] neg_lo:[1,0,0]
    v_cvt_pk_bf16_f32 v126, v104, -v105
    ds_write_addtid_b32 v126 offset:24768
    v_pk_mul_f32 v[108:109], v[92:93], v[116:117] op_sel_hi:[1,0]
    v_pk_fma_f32 v[108:109], v[92:93], v[116:117], v[108:109] op_sel:[1,1,0] op_sel_hi:[0,1,1] neg_lo:[1,0,0]
    v_cvt_pk_bf16_f32 v127, v106, -v107
    ds_write_addtid_b32 v127 offset:26832
    v_pk_mul_f32 v[110:111], v[94:95], v[116:117] op_sel_hi:[1,0]
    v_pk_fma_f32 v[110:111], v[94:95], v[116:117], v[110:111] op_sel:[1,1,0] op_sel_hi:[0,1,1] neg_lo:[1,0,0]
    v_cvt_pk_bf16_f32 v128, v108, -v109
    ds_write_addtid_b32 v128 offset:28896
    v_pk_mul_f32 v[48:49], v[46:47], v[32:33] op_sel_hi:[1,0]
    v_pk_fma_f32 v[48:49], v[46:47], v[32:33], v[48:49] op_sel:[1,1,0] op_sel_hi:[0,1,1] neg_lo:[1,0,0]
    v_cvt_pk_bf16_f32 v129, v110, -v111
    ds_write_addtid_b32 v129 offset:30960
    v_pk_mul_f32 v[50:51], v[46:47], v[34:35] op_sel_hi:[1,0]
    v_pk_fma_f32 v[50:51], v[46:47], v[34:35], v[50:51] op_sel:[1,1,0] op_sel_hi:[0,1,1] neg_lo:[1,0,0]
    v_cvt_pk_bf16_f32 v126, v48, v49
    ds_write_addtid_b32 v126 offset:49536
    v_pk_mul_f32 v[52:53], v[46:47], v[36:37] op_sel_hi:[1,0]
    v_pk_fma_f32 v[52:53], v[46:47], v[36:37], v[52:53] op_sel:[1,1,0] op_sel_hi:[0,1,1] neg_lo:[1,0,0]
    v_cvt_pk_bf16_f32 v127, v50, v51
    ds_write_addtid_b32 v127 offset:51600
    v_pk_mul_f32 v[54:55], v[46:47], v[38:39] op_sel_hi:[1,0]
    v_pk_fma_f32 v[54:55], v[46:47], v[38:39], v[54:55] op_sel:[1,1,0] op_sel_hi:[0,1,1] neg_lo:[1,0,0]
    v_cvt_pk_bf16_f32 v128, v52, v53
    ds_write_addtid_b32 v128 offset:53664
    v_pk_mul_f32 v[56:57], v[46:47], v[40:41] op_sel_hi:[1,0]
    v_pk_fma_f32 v[56:57], v[46:47], v[40:41], v[56:57] op_sel:[1,1,0] op_sel_hi:[0,1,1] neg_lo:[1,0,0]
    v_cvt_pk_bf16_f32 v129, v54, v55
    ds_write_addtid_b32 v129 offset:55728
    v_pk_mul_f32 v[58:59], v[46:47], v[42:43] op_sel_hi:[1,0]
    v_pk_fma_f32 v[58:59], v[46:47], v[42:43], v[58:59] op_sel:[1,1,0] op_sel_hi:[0,1,1] neg_lo:[1,0,0]
    s_mov_b32 m0, s57
    v_cvt_pk_bf16_f32 v126, v56, v57
    ds_write_addtid_b32 v126 offset:0
    v_pk_mul_f32 v[60:61], v[46:47], v[44:45] op_sel_hi:[1,0]
    v_pk_fma_f32 v[60:61], v[46:47], v[44:45], v[60:61] op_sel:[1,1,0] op_sel_hi:[0,1,1] neg_lo:[1,0,0]
    v_cvt_pk_bf16_f32 v127, v58, v59
    ds_write_addtid_b32 v127 offset:2064
    v_cvt_pk_bf16_f32 v128, v60, v61
    ds_write_addtid_b32 v128 offset:4128
    v_cvt_pk_bf16_f32 v129, v64, v65
    ds_write_addtid_b32 v129 offset:6192
    global_load_dwordx2 v[144:145], v152, s[16:17]
    v_pk_mul_f32 v[118:119], v[64:65], v[34:35] op_sel_hi:[1,0]
    v_pk_fma_f32 v[118:119], v[64:65], v[34:35], v[118:119] op_sel:[1,1,0] op_sel_hi:[0,1,1] neg_lo:[1,0,0]
    v_pk_mul_f32 v[120:121], v[64:65], v[38:39] op_sel_hi:[1,0]
    v_pk_fma_f32 v[120:121], v[64:65], v[38:39], v[120:121] op_sel:[1,1,0] op_sel_hi:[0,1,1] neg_lo:[1,0,0]
    v_cvt_pk_bf16_f32 v126, v118, v119
    ds_write_addtid_b32 v126 offset:8256
    v_pk_mul_f32 v[122:123], v[64:65], v[42:43] op_sel_hi:[1,0]
    v_pk_fma_f32 v[122:123], v[64:65], v[42:43], v[122:123] op_sel:[1,1,0] op_sel_hi:[0,1,1] neg_lo:[1,0,0]
    v_cvt_pk_bf16_f32 v127, v120, v121
    ds_write_addtid_b32 v127 offset:10320
    v_pk_mul_f32 v[124:125], v[64:65], v[46:47] op_sel_hi:[1,0]
    v_pk_fma_f32 v[124:125], v[64:65], v[46:47], v[124:125] op_sel:[1,1,0] op_sel_hi:[0,1,1] neg_lo:[1,0,0]
    v_cvt_pk_bf16_f32 v128, v122, v123
    ds_write_addtid_b32 v128 offset:12384
    v_pk_mul_f32 v[118:119], v[64:65], v[50:51] op_sel_hi:[1,0]
    v_pk_fma_f32 v[118:119], v[64:65], v[50:51], v[118:119] op_sel:[1,1,0] op_sel_hi:[0,1,1] neg_lo:[1,0,0]
    v_cvt_pk_bf16_f32 v129, v124, v125
    ds_write_addtid_b32 v129 offset:14448
    v_pk_mul_f32 v[120:121], v[64:65], v[54:55] op_sel_hi:[1,0]
    v_pk_fma_f32 v[120:121], v[64:65], v[54:55], v[120:121] op_sel:[1,1,0] op_sel_hi:[0,1,1] neg_lo:[1,0,0]
    v_cvt_pk_bf16_f32 v126, v118, v119
    ds_write_addtid_b32 v126 offset:16512
    v_pk_mul_f32 v[122:123], v[64:65], v[58:59] op_sel_hi:[1,0]
    v_pk_fma_f32 v[122:123], v[64:65], v[58:59], v[122:123] op_sel:[1,1,0] op_sel_hi:[0,1,1] neg_lo:[1,0,0]
    v_cvt_pk_bf16_f32 v127, v120, v121
    ds_write_addtid_b32 v127 offset:18576
    v_pk_mul_f32 v[124:125], v[64:65], v[62:63] op_sel_hi:[1,0]
    v_pk_fma_f32 v[124:125], v[64:65], v[62:63], v[124:125] op_sel:[1,1,0] op_sel_hi:[0,1,1] neg_lo:[1,0,0]
    v_cvt_pk_bf16_f32 v128, v122, v123
    ds_write_addtid_b32 v128 offset:20640
    v_pk_mul_f32 v[118:119], v[66:67], v[38:39] op_sel_hi:[1,0]
    v_pk_fma_f32 v[118:119], v[66:67], v[38:39], v[118:119] op_sel:[1,1,0] op_sel_hi:[0,1,1] neg_lo:[1,0,0]
    v_cvt_pk_bf16_f32 v129, v124, v125
    ds_write_addtid_b32 v129 offset:22704
    v_pk_mul_f32 v[120:121], v[66:67], v[46:47] op_sel_hi:[1,0]
    v_pk_fma_f32 v[120:121], v[66:67], v[46:47], v[120:121] op_sel:[1,1,0] op_sel_hi:[0,1,1] neg_lo:[1,0,0]
    v_cvt_pk_bf16_f32 v126, v118, v119
    ds_write_addtid_b32 v126 offset:24768
    v_pk_mul_f32 v[122:123], v[66:67], v[54:55] op_sel_hi:[1,0]
    v_pk_fma_f32 v[122:123], v[66:67], v[54:55], v[122:123] op_sel:[1,1,0] op_sel_hi:[0,1,1] neg_lo:[1,0,0]
    v_cvt_pk_bf16_f32 v127, v120, v121
    ds_write_addtid_b32 v127 offset:26832
    v_pk_mul_f32 v[124:125], v[66:67], v[62:63] op_sel_hi:[1,0]
    v_pk_fma_f32 v[124:125], v[66:67], v[62:63], v[124:125] op_sel:[1,1,0] op_sel_hi:[0,1,1] neg_lo:[1,0,0]
    v_cvt_pk_bf16_f32 v128, v122, v123
    ds_write_addtid_b32 v128 offset:28896
    v_pk_mul_f32 v[118:119], v[68:69], v[38:39] op_sel_hi:[1,0]
    v_pk_fma_f32 v[118:119], v[68:69], v[38:39], v[118:119] op_sel:[1,1,0] op_sel_hi:[0,1,1] neg_lo:[1,0,0]
    v_cvt_pk_bf16_f32 v129, v124, v125
    ds_write_addtid_b32 v129 offset:30960
    v_pk_mul_f32 v[120:121], v[68:69], v[46:47] op_sel_hi:[1,0]
    v_pk_fma_f32 v[120:121], v[68:69], v[46:47], v[120:121] op_sel:[1,1,0] op_sel_hi:[0,1,1] neg_lo:[1,0,0]
    v_cvt_pk_bf16_f32 v126, v118, v119
    ds_write_addtid_b32 v126 offset:33024
    v_pk_mul_f32 v[122:123], v[68:69], v[54:55] op_sel_hi:[1,0]
    v_pk_fma_f32 v[122:123], v[68:69], v[54:55], v[122:123] op_sel:[1,1,0] op_sel_hi:[0,1,1] neg_lo:[1,0,0]
    v_cvt_pk_bf16_f32 v127, v120, v121
    ds_write_addtid_b32 v127 offset:35088
    v_pk_mul_f32 v[124:125], v[68:69], v[62:63] op_sel_hi:[1,0]
    v_pk_fma_f32 v[124:125], v[68:69], v[62:63], v[124:125] op_sel:[1,1,0] op_sel_hi:[0,1,1] neg_lo:[1,0,0]
    v_cvt_pk_bf16_f32 v128, v122, v123
    ds_write_addtid_b32 v128 offset:37152
    v_pk_mul_f32 v[118:119], v[70:71], v[46:47] op_sel_hi:[1,0]
    v_pk_fma_f32 v[118:119], v[70:71], v[46:47], v[118:119] op_sel:[1,1,0] op_sel_hi:[0,1,1] neg_lo:[1,0,0]
    v_cvt_pk_bf16_f32 v129, v124, v125
    ds_write_addtid_b32 v129 offset:39216
    v_pk_mul_f32 v[120:121], v[70:71], v[62:63] op_sel_hi:[1,0]
    v_pk_fma_f32 v[120:121], v[70:71], v[62:63], v[120:121] op_sel:[1,1,0] op_sel_hi:[0,1,1] neg_lo:[1,0,0]
    v_cvt_pk_bf16_f32 v126, v118, v119
    ds_write_addtid_b32 v126 offset:41280
    v_pk_mul_f32 v[122:123], v[72:73], v[46:47] op_sel_hi:[1,0]
    v_pk_fma_f32 v[122:123], v[72:73], v[46:47], v[122:123] op_sel:[1,1,0] op_sel_hi:[0,1,1] neg_lo:[1,0,0]
    v_cvt_pk_bf16_f32 v127, v120, v121
    ds_write_addtid_b32 v127 offset:43344
    v_pk_mul_f32 v[124:125], v[72:73], v[62:63] op_sel_hi:[1,0]
    v_pk_fma_f32 v[124:125], v[72:73], v[62:63], v[124:125] op_sel:[1,1,0] op_sel_hi:[0,1,1] neg_lo:[1,0,0]
    v_cvt_pk_bf16_f32 v128, v122, v123
    ds_write_addtid_b32 v128 offset:45408
    v_pk_mul_f32 v[118:119], v[74:75], v[46:47] op_sel_hi:[1,0]
    v_pk_fma_f32 v[118:119], v[74:75], v[46:47], v[118:119] op_sel:[1,1,0] op_sel_hi:[0,1,1] neg_lo:[1,0,0]
    v_cvt_pk_bf16_f32 v129, v124, v125
    ds_write_addtid_b32 v129 offset:47472
    v_pk_mul_f32 v[120:121], v[74:75], v[62:63] op_sel_hi:[1,0]
    v_pk_fma_f32 v[120:121], v[74:75], v[62:63], v[120:121] op_sel:[1,1,0] op_sel_hi:[0,1,1] neg_lo:[1,0,0]
    v_cvt_pk_bf16_f32 v126, v118, v119
    ds_write_addtid_b32 v126 offset:49536
    v_pk_mul_f32 v[122:123], v[76:77], v[46:47] op_sel_hi:[1,0]
    v_pk_fma_f32 v[122:123], v[76:77], v[46:47], v[122:123] op_sel:[1,1,0] op_sel_hi:[0,1,1] neg_lo:[1,0,0]
    v_cvt_pk_bf16_f32 v127, v120, v121
    ds_write_addtid_b32 v127 offset:51600
    v_pk_mul_f32 v[124:125], v[76:77], v[62:63] op_sel_hi:[1,0]
    v_pk_fma_f32 v[124:125], v[76:77], v[62:63], v[124:125] op_sel:[1,1,0] op_sel_hi:[0,1,1] neg_lo:[1,0,0]
    v_cvt_pk_bf16_f32 v128, v122, v123
    ds_write_addtid_b32 v128 offset:53664
    v_cvt_pk_bf16_f32 v129, v124, v125
    ds_write_addtid_b32 v129 offset:55728
    global_load_dwordx2 v[146:147], v153, s[16:17]
    v_lshlrev_b32 v22, 5, v2
    v_lshl_add_u32 v4, v3, 3, v22
    v_lshl_add_u32 v22, v3, 4, v22
    v_add_u32 v7, s49, v22
    v_lshlrev_b32 v22, 5, v2
    v_lshrrev_b32 v23, 1, v3
    v_lshl_add_u32 v22, v23, 4, v22
    v_and_b32 v23, 1, v3
    v_lshl_add_u32 v22, v23, 9, v22
    s_add_u32 s48, s50, 1072
    v_sub_u32 v5, s48, v22
    v_cmp_eq_u32 vcc, 0, v1
    v_mov_b32 v249, 0
    v_mov_b32 v250, 0
    v_mov_b32 v251, 0
    v_cndmask_b32 v248, 0, v21, vcc
    s_waitcnt lgkmcnt(0)
    s_barrier
    s_cmp_eq_u32 s45, 0
    s_cbranch_scc0 B_waveB
    ds_read_b128 v[32:35], v130 offset:0
    ds_read_b128 v[64:67], v131 offset:0
    ds_read_b128 v[36:39], v130 offset:16
    ds_read_b128 v[68:71], v131 offset:16
    ds_read_b128 v[40:43], v130 offset:32
    ds_read_b128 v[72:75], v131 offset:32
    ds_read_b128 v[44:47], v130 offset:48
    ds_read_b128 v[76:79], v131 offset:48
    ds_read_b128 v[48:51], v130 offset:64
    ds_read_b128 v[80:83], v131 offset:64
    ds_read_b128 v[52:55], v130 offset:80
    ds_read_b128 v[84:87], v131 offset:80
    s_waitcnt lgkmcnt(10)
    v_mfma_f32_16x16x32_bf16 v[248:251], v[64:67], v[32:35], 0
    ds_read_b128 v[56:59], v130 offset:96
    ds_read_b128 v[88:91], v131 offset:96
    s_waitcnt lgkmcnt(10)
    v_mfma_f32_16x16x32_bf16 v[248:251], v[68:71], v[36:39], v[248:251]
    ds_read_b128 v[60:63], v130 offset:112
    ds_read_b128 v[92:95], v131 offset:112
    s_waitcnt lgkmcnt(10)
    v_mfma_f32_16x16x32_bf16 v[248:251], v[72:75], v[40:43], v[248:251]
    s_waitcnt lgkmcnt(8)
    v_mfma_f32_16x16x32_bf16 v[248:251], v[76:79], v[44:47], v[248:251]
    s_waitcnt lgkmcnt(6)
    v_mfma_f32_16x16x32_bf16 v[248:251], v[80:83], v[48:51], v[248:251]
    s_waitcnt lgkmcnt(4)
    v_mfma_f32_16x16x32_bf16 v[248:251], v[84:87], v[52:55], v[248:251]
    s_waitcnt lgkmcnt(2)
    v_mfma_f32_16x16x32_bf16 v[248:251], v[88:91], v[56:59], v[248:251]
    s_waitcnt lgkmcnt(0)
    v_mfma_f32_16x16x32_bf16 v[248:251], v[92:95], v[60:63], v[248:251]
    v_lshlrev_b32 v22, 7, v3
    v_lshl_add_u32 v23, v2, 3, v22
    v_sub_u32 v23, 2712, v23
    v_add_u32 v24, 4, v23
    v_lshl_add_u32 v25, v2, 2, v22
    v_sub_u32 v25, 3356, v25
    v_subrev_u32 v26, 64, v25
    v_cmp_gt_u32 vcc, 2, v3
    s_nop 1
    v_cndmask_b32 v16, v25, v24, vcc
    v_cndmask_b32 v17, v26, v23, vcc
    v_add_u32 v16, s50, v16
    v_add_u32 v17, s50, v17
    v_cvt_pk_bf16_f32 v22, v249, v248
    v_cvt_pk_bf16_f32 v23, v251, v250
    ds_write_b32 v16, v22
    ds_write_b32 v17, v23
    s_waitcnt vmcnt(0)
    v_perm_b32 v156, v142, v140, v154
    v_perm_b32 v157, v146, v144, v154
    ds_write_b32 v148, v156 offset:0
    ds_write_b32 v149, v157 offset:0
    v_perm_b32 v158, v142, v140, v155
    v_perm_b32 v159, v146, v144, v155
    ds_write_b32 v148, v158 offset:4608
    ds_write_b32 v149, v159 offset:4608
    v_perm_b32 v160, v143, v141, v154
    v_perm_b32 v161, v147, v145, v154
    ds_write_b32 v148, v160 offset:9216
    ds_write_b32 v149, v161 offset:9216
    v_perm_b32 v162, v143, v141, v155
    v_perm_b32 v163, v147, v145, v155
    ds_write_b32 v148, v162 offset:13824
    ds_write_b32 v149, v163 offset:13824
    s_add_u32 s48, s50, 2
    v_add_u32 v10, s48, v6
    v_lshlrev_b32 v22, 5, v3
    v_lshlrev_b32 v23, 3, v2
    v_sub_u32 v22, v22, v23
    s_add_u32 s48, s50, 2456
    v_add_u32 v12, s48, v22
    v_ashrrev_i32 v22, 1, v22
    s_add_u32 s48, s50, 2908
    v_add_u32 v13, s48, v22
    s_waitcnt lgkmcnt(0)
    s_barrier
    ds_read_b128 v[32:35], v7 offset:480
    ds_read_b128 v[64:67], v7 offset:464
    ds_read_b128 v[36:39], v7 offset:992
    ds_read_b128 v[40:43], v7 offset:1504
    ds_read_b128 v[44:47], v7 offset:2016
    ds_read_b128 v[48:51], v7 offset:2528
    ds_read_b128 v[52:55], v7 offset:3040
    ds_read_b128 v[56:59], v7 offset:3552
    ds_read_b128 v[60:63], v7 offset:4064
    s_waitcnt lgkmcnt(7)
    v_add_u32 v16, 512, v10
    v_mov_b32 v22, s50
    v_mfma_f32_16x16x32_bf16 v[124:127], v[32:35], v[172:175], 0
    ds_read2_b32 v[112:113], v16 offset0:135 offset1:136
    ds_read2_b32 v[114:115], v16 offset0:137 offset1:138
    ds_read2_b32 v[116:117], v10 offset0:135 offset1:136
    v_mfma_f32_16x16x32_bf16 v[128:131], v[32:35], v[176:179], 0
    ds_read2_b32 v[118:119], v10 offset0:137 offset1:138
    ds_read2_b32 v[120:121], v10 offset0:7 offset1:8
    ds_read2_b32 v[122:123], v10 offset0:9 offset1:10
    v_mfma_f32_16x16x32_bf16 v[132:135], v[32:35], v[180:183], 0
    ds_read_u16 v24, v22 offset:64
    ds_read_u16 v25, v22 offset:2464
    ds_read_b64 v[72:73], v12 offset:256
    v_mfma_f32_16x16x32_bf16 v[136:139], v[64:67], v[184:187], 0
    ds_read_b64 v[74:75], v12 offset:264
    ds_read_b64 v[76:77], v12 offset:272
    ds_read_b64 v[78:79], v12 offset:280
    v_mfma_f32_16x16x32_bf16 v[140:143], v[32:35], v[188:191], 0
    ds_read_b64 v[80:81], v12 offset:128
    ds_read_b64 v[82:83], v12 offset:136
    ds_read_b64 v[84:85], v12 offset:144
    v_mfma_f32_16x16x32_bf16 v[144:147], v[64:67], v[192:195], 0
    ds_read_b64 v[86:87], v12 offset:152
    ds_read_b64 v[88:89], v12 offset:0
    ds_read_b64 v[90:91], v12 offset:8
    ds_read_b64 v[92:93], v12 offset:16
    ds_read_b64 v[94:95], v12 offset:24
    ds_read2_b32 v[96:97], v13 offset0:48 offset1:49
    ds_read2_b32 v[98:99], v13 offset0:50 offset1:51
    ds_read2_b32 v[100:101], v13 offset0:32 offset1:33
    ds_read2_b32 v[102:103], v13 offset0:34 offset1:35
    ds_read2_b32 v[104:105], v13 offset0:16 offset1:17
    ds_read2_b32 v[106:107], v13 offset0:18 offset1:19
    ds_read2_b32 v[108:109], v13 offset0:0 offset1:1
    ds_read2_b32 v[110:111], v13 offset0:2 offset1:3
    ds_read_b128 v[68:71], v7 offset:976
    s_waitcnt lgkmcnt(15)
    s_waitcnt lgkmcnt(0)
    v_mfma_f32_16x16x32_bf16 v[204:207], v[112:115], v[32:35], 0
    v_mfma_f32_16x16x32_bf16 v[208:211], v[112:115], v[36:39], 0
    v_mfma_f32_16x16x32_bf16 v[212:215], v[112:115], v[40:43], 0
    v_mfma_f32_16x16x32_bf16 v[216:219], v[112:115], v[44:47], 0
    v_mfma_f32_16x16x32_bf16 v[220:223], v[112:115], v[48:51], 0
    v_mfma_f32_16x16x32_bf16 v[224:227], v[112:115], v[52:55], 0
    v_mfma_f32_16x16x32_bf16 v[228:231], v[112:115], v[56:59], 0
    v_mfma_f32_16x16x32_bf16 v[232:235], v[112:115], v[60:63], 0
    v_cvt_pk_bf16_f32 v148, v136, v132
    v_cvt_pk_bf16_f32 v149, v128, v124
    v_cvt_pk_bf16_f32 v150, v137, v133
    v_cvt_pk_bf16_f32 v151, v129, v125
    v_cvt_pk_bf16_f32 v152, v138, v134
    v_cvt_pk_bf16_f32 v153, v130, v126
    v_cvt_pk_bf16_f32 v154, v139, v135
    v_cvt_pk_bf16_f32 v155, v131, v127
    v_cvt_pk_bf16_f32 v156, v144, v140
    v_cvt_pk_bf16_f32 v157, v145, v141
    v_cvt_pk_bf16_f32 v158, v146, v142
    v_cvt_pk_bf16_f32 v159, v147, v143
    v_lshl_or_b32 v24, v24, 16, v24
    v_lshl_or_b32 v25, v25, 16, v25
    v_and_or_b32 v120, v196, v24, v120
    v_and_b32 v200, v200, v25
    v_and_or_b32 v121, v197, v24, v121
    v_and_b32 v201, v201, v25
    v_and_or_b32 v122, v198, v24, v122
    v_and_b32 v202, v202, v25
    v_and_or_b32 v123, v199, v24, v123
    v_and_b32 v203, v203, v25
    s_waitcnt lgkmcnt(0)
    v_mfma_f32_16x16x32_bf16 v[124:127], v[36:39], v[172:175], 0
    v_mfma_f32_16x16x32_bf16 v[128:131], v[36:39], v[176:179], 0
    v_mfma_f32_16x16x32_bf16 v[132:135], v[36:39], v[180:183], 0
    v_mfma_f32_16x16x32_bf16 v[136:139], v[68:71], v[184:187], 0
    v_mfma_f32_16x16x32_bf16 v[140:143], v[36:39], v[188:191], 0
    v_mfma_f32_16x16x32_bf16 v[144:147], v[68:71], v[192:195], 0
    ds_read_b128 v[64:67], v7 offset:1488
    v_mfma_f32_16x16x32_bf16 v[212:215], v[148:151], v[72:75], v[212:215]
    v_mfma_f32_16x16x32_bf16 v[212:215], v[152:155], v[76:79], v[212:215]
    v_mfma_f32_16x16x32_bf16 v[216:219], v[148:151], v[80:83], v[216:219]
    v_mfma_f32_16x16x32_bf16 v[216:219], v[152:155], v[84:87], v[216:219]
    v_mfma_f32_16x16x32_bf16 v[220:223], v[148:151], v[88:91], v[220:223]
    v_mfma_f32_16x16x32_bf16 v[220:223], v[152:155], v[92:95], v[220:223]
    v_mfma_f32_16x16x32_bf16 v[220:223], v[156:159], v[96:99], v[220:223]
    v_mfma_f32_16x16x32_bf16 v[224:227], v[156:159], v[100:103], v[224:227]
    v_mfma_f32_16x16x32_bf16 v[228:231], v[156:159], v[104:107], v[228:231]
    v_mfma_f32_16x16x32_bf16 v[232:235], v[156:159], v[108:111], v[232:235]
    s_lshl_b32 s48, s4, 15
    v_lshl_add_u32 v14, v0, 4, s48
    global_load_dwordx4 v[236:239], v14, s[20:21]
    v_add_u32 v14, 4096, v14
    global_load_dwordx4 v[236:239], v14, s[20:21]
    v_mfma_f32_16x16x32_bf16 v[208:211], v[116:119], v[32:35], v[208:211]
    v_mfma_f32_16x16x32_bf16 v[212:215], v[116:119], v[36:39], v[212:215]
    v_mfma_f32_16x16x32_bf16 v[216:219], v[116:119], v[40:43], v[216:219]
    v_cvt_pk_bf16_f32 v160, v136, v132
    v_cvt_pk_bf16_f32 v161, v128, v124
    v_cvt_pk_bf16_f32 v162, v137, v133
    v_cvt_pk_bf16_f32 v163, v129, v125
    v_cvt_pk_bf16_f32 v164, v138, v134
    v_cvt_pk_bf16_f32 v165, v130, v126
    v_cvt_pk_bf16_f32 v166, v139, v135
    v_cvt_pk_bf16_f32 v167, v131, v127
    v_cvt_pk_bf16_f32 v168, v144, v140
    v_cvt_pk_bf16_f32 v169, v145, v141
    v_cvt_pk_bf16_f32 v170, v146, v142
    v_cvt_pk_bf16_f32 v171, v147, v143
    s_waitcnt lgkmcnt(0)
    v_mfma_f32_16x16x32_bf16 v[124:127], v[40:43], v[172:175], 0
    v_mfma_f32_16x16x32_bf16 v[128:131], v[40:43], v[176:179], 0
    v_mfma_f32_16x16x32_bf16 v[132:135], v[40:43], v[180:183], 0
    v_mfma_f32_16x16x32_bf16 v[136:139], v[64:67], v[184:187], 0
    v_mfma_f32_16x16x32_bf16 v[140:143], v[40:43], v[188:191], 0
    v_mfma_f32_16x16x32_bf16 v[144:147], v[64:67], v[192:195], 0
    ds_read_b128 v[68:71], v7 offset:2000
    v_mfma_f32_16x16x32_bf16 v[216:219], v[160:163], v[72:75], v[216:219]
    v_mfma_f32_16x16x32_bf16 v[216:219], v[164:167], v[76:79], v[216:219]
    v_mfma_f32_16x16x32_bf16 v[220:223], v[160:163], v[80:83], v[220:223]
    v_mfma_f32_16x16x32_bf16 v[220:223], v[164:167], v[84:87], v[220:223]
    v_mfma_f32_16x16x32_bf16 v[224:227], v[160:163], v[88:91], v[224:227]
    v_mfma_f32_16x16x32_bf16 v[224:227], v[164:167], v[92:95], v[224:227]
    v_mfma_f32_16x16x32_bf16 v[224:227], v[168:171], v[96:99], v[224:227]
    v_mfma_f32_16x16x32_bf16 v[228:231], v[168:171], v[100:103], v[228:231]
    v_mfma_f32_16x16x32_bf16 v[232:235], v[168:171], v[104:107], v[232:235]
    v_add_u32 v14, 4096, v14
    global_load_dwordx4 v[236:239], v14, s[20:21]
    v_add_u32 v14, 4096, v14
    global_load_dwordx4 v[236:239], v14, s[20:21]
    v_mfma_f32_16x16x32_bf16 v[220:223], v[116:119], v[44:47], v[220:223]
    v_mfma_f32_16x16x32_bf16 v[224:227], v[116:119], v[48:51], v[224:227]
    v_mfma_f32_16x16x32_bf16 v[228:231], v[116:119], v[52:55], v[228:231]
    v_cvt_pk_bf16_f32 v148, v136, v132
    v_cvt_pk_bf16_f32 v149, v128, v124
    v_cvt_pk_bf16_f32 v150, v137, v133
    v_cvt_pk_bf16_f32 v151, v129, v125
    v_cvt_pk_bf16_f32 v152, v138, v134
    v_cvt_pk_bf16_f32 v153, v130, v126
    v_cvt_pk_bf16_f32 v154, v139, v135
    v_cvt_pk_bf16_f32 v155, v131, v127
    v_cvt_pk_bf16_f32 v156, v144, v140
    v_cvt_pk_bf16_f32 v157, v145, v141
    v_cvt_pk_bf16_f32 v158, v146, v142
    v_cvt_pk_bf16_f32 v159, v147, v143
    s_waitcnt lgkmcnt(0)
    v_mfma_f32_16x16x32_bf16 v[124:127], v[44:47], v[172:175], 0
    v_mfma_f32_16x16x32_bf16 v[128:131], v[44:47], v[176:179], 0
    v_mfma_f32_16x16x32_bf16 v[132:135], v[44:47], v[180:183], 0
    v_mfma_f32_16x16x32_bf16 v[136:139], v[68:71], v[184:187], 0
    v_mfma_f32_16x16x32_bf16 v[140:143], v[44:47], v[188:191], 0
    v_mfma_f32_16x16x32_bf16 v[144:147], v[68:71], v[192:195], 0
    ds_read_b128 v[64:67], v7 offset:2512
    v_mfma_f32_16x16x32_bf16 v[220:223], v[148:151], v[72:75], v[220:223]
    v_mfma_f32_16x16x32_bf16 v[220:223], v[152:155], v[76:79], v[220:223]
    v_mfma_f32_16x16x32_bf16 v[224:227], v[148:151], v[80:83], v[224:227]
    v_mfma_f32_16x16x32_bf16 v[224:227], v[152:155], v[84:87], v[224:227]
    v_mfma_f32_16x16x32_bf16 v[228:231], v[148:151], v[88:91], v[228:231]
    v_mfma_f32_16x16x32_bf16 v[228:231], v[152:155], v[92:95], v[228:231]
    v_mfma_f32_16x16x32_bf16 v[228:231], v[156:159], v[96:99], v[228:231]
    v_mfma_f32_16x16x32_bf16 v[232:235], v[156:159], v[100:103], v[232:235]
    v_add_u32 v14, 4096, v14
    global_load_dwordx4 v[236:239], v14, s[20:21]
    v_add_u32 v14, 4096, v14
    global_load_dwordx4 v[236:239], v14, s[20:21]
    v_mfma_f32_16x16x32_bf16 v[232:235], v[116:119], v[56:59], v[232:235]
    v_mfma_f32_16x16x32_bf16 v[212:215], v[120:123], v[32:35], v[212:215]
    v_mfma_f32_16x16x32_bf16 v[216:219], v[120:123], v[36:39], v[216:219]
    v_cvt_pk_bf16_f32 v160, v136, v132
    v_cvt_pk_bf16_f32 v161, v128, v124
    v_cvt_pk_bf16_f32 v162, v137, v133
    v_cvt_pk_bf16_f32 v163, v129, v125
    v_cvt_pk_bf16_f32 v164, v138, v134
    v_cvt_pk_bf16_f32 v165, v130, v126
    v_cvt_pk_bf16_f32 v166, v139, v135
    v_cvt_pk_bf16_f32 v167, v131, v127
    v_cvt_pk_bf16_f32 v168, v144, v140
    v_cvt_pk_bf16_f32 v169, v145, v141
    v_cvt_pk_bf16_f32 v170, v146, v142
    v_cvt_pk_bf16_f32 v171, v147, v143
    s_waitcnt lgkmcnt(0)
    v_mfma_f32_16x16x32_bf16 v[124:127], v[48:51], v[172:175], 0
    v_mfma_f32_16x16x32_bf16 v[128:131], v[48:51], v[176:179], 0
    v_mfma_f32_16x16x32_bf16 v[132:135], v[48:51], v[180:183], 0
    v_mfma_f32_16x16x32_bf16 v[136:139], v[64:67], v[184:187], 0
    ds_read_b128 v[68:71], v7 offset:3024
    v_mfma_f32_16x16x32_bf16 v[224:227], v[160:163], v[72:75], v[224:227]
    v_mfma_f32_16x16x32_bf16 v[224:227], v[164:167], v[76:79], v[224:227]
    v_mfma_f32_16x16x32_bf16 v[228:231], v[160:163], v[80:83], v[228:231]
    v_mfma_f32_16x16x32_bf16 v[228:231], v[164:167], v[84:87], v[228:231]
    v_mfma_f32_16x16x32_bf16 v[232:235], v[160:163], v[88:91], v[232:235]
    v_mfma_f32_16x16x32_bf16 v[232:235], v[164:167], v[92:95], v[232:235]
    v_mfma_f32_16x16x32_bf16 v[232:235], v[168:171], v[96:99], v[232:235]
    v_add_u32 v14, 4096, v14
    global_load_dwordx4 v[236:239], v14, s[20:21]
    v_add_u32 v14, 4096, v14
    global_load_dwordx4 v[236:239], v14, s[20:21]
    v_mfma_f32_16x16x32_bf16 v[220:223], v[120:123], v[40:43], v[220:223]
    v_mfma_f32_16x16x32_bf16 v[224:227], v[120:123], v[44:47], v[224:227]
    v_mfma_f32_16x16x32_bf16 v[228:231], v[120:123], v[48:51], v[228:231]
    v_cvt_pk_bf16_f32 v148, v136, v132
    v_cvt_pk_bf16_f32 v149, v128, v124
    v_cvt_pk_bf16_f32 v150, v137, v133
    v_cvt_pk_bf16_f32 v151, v129, v125
    v_cvt_pk_bf16_f32 v152, v138, v134
    v_cvt_pk_bf16_f32 v153, v130, v126
    v_cvt_pk_bf16_f32 v154, v139, v135
    v_cvt_pk_bf16_f32 v155, v131, v127
    s_waitcnt lgkmcnt(0)
    v_mfma_f32_16x16x32_bf16 v[124:127], v[52:55], v[172:175], 0
    v_mfma_f32_16x16x32_bf16 v[128:131], v[52:55], v[176:179], 0
    v_mfma_f32_16x16x32_bf16 v[132:135], v[52:55], v[180:183], 0
    v_mfma_f32_16x16x32_bf16 v[136:139], v[68:71], v[184:187], 0
    v_mfma_f32_16x16x32_bf16 v[228:231], v[148:151], v[72:75], v[228:231]
    v_mfma_f32_16x16x32_bf16 v[228:231], v[152:155], v[76:79], v[228:231]
    v_mfma_f32_16x16x32_bf16 v[232:235], v[148:151], v[80:83], v[232:235]
    v_mfma_f32_16x16x32_bf16 v[232:235], v[152:155], v[84:87], v[232:235]
    v_mfma_f32_16x16x32_bf16 v[232:235], v[120:123], v[52:55], v[232:235]
    v_mfma_f32_16x16x32_bf16 v[220:223], v[200:203], v[32:35], v[220:223]
    v_mfma_f32_16x16x32_bf16 v[224:227], v[200:203], v[36:39], v[224:227]
    s_nop 0
    v_cvt_pk_bf16_f32 v160, v136, v132
    v_cvt_pk_bf16_f32 v161, v128, v124
    v_cvt_pk_bf16_f32 v162, v137, v133
    v_cvt_pk_bf16_f32 v163, v129, v125
    v_cvt_pk_bf16_f32 v164, v138, v134
    v_cvt_pk_bf16_f32 v165, v130, v126
    v_cvt_pk_bf16_f32 v166, v139, v135
    v_cvt_pk_bf16_f32 v167, v131, v127
    v_mfma_f32_16x16x32_bf16 v[228:231], v[200:203], v[40:43], v[228:231]
    v_mfma_f32_16x16x32_bf16 v[232:235], v[200:203], v[44:47], v[232:235]
    v_mfma_f32_16x16x32_bf16 v[232:235], v[160:163], v[72:75], v[232:235]
    v_mfma_f32_16x16x32_bf16 v[232:235], v[164:167], v[76:79], v[232:235]
    s_nop 7
    s_branch B_epi
B_waveB:
    s_setprio 1
    ds_read_b128 v[32:35], v130 offset:0
    ds_read_b128 v[64:67], v131 offset:0
    ds_read_b128 v[96:99], v132 offset:0
    ds_read_b128 v[36:39], v130 offset:16
    ds_read_b128 v[68:71], v131 offset:16
    ds_read_b128 v[100:103], v132 offset:16
    ds_read_b128 v[40:43], v130 offset:32
    ds_read_b128 v[72:75], v131 offset:32
    ds_read_b128 v[104:107], v132 offset:32
    ds_read_b128 v[44:47], v130 offset:48
    ds_read_b128 v[76:79], v131 offset:48
    ds_read_b128 v[108:111], v132 offset:48
    s_waitcnt lgkmcnt(10)
    v_mfma_f32_16x16x32_bf16 v[248:251], v[64:67], v[32:35], v[248:251]
    ds_read_b128 v[48:51], v130 offset:64
    ds_read_b128 v[80:83], v131 offset:64
    s_waitcnt lgkmcnt(11)
    v_mfma_f32_16x16x32_bf16 v[252:255], v[96:99], v[32:35], 0
    ds_read_b128 v[112:115], v132 offset:64
    s_waitcnt lgkmcnt(10)
    v_mfma_f32_16x16x32_bf16 v[248:251], v[68:71], v[36:39], v[248:251]
    ds_read_b128 v[52:55], v130 offset:80
    ds_read_b128 v[84:87], v131 offset:80
    s_waitcnt lgkmcnt(11)
    v_mfma_f32_16x16x32_bf16 v[252:255], v[100:103], v[36:39], v[252:255]
    ds_read_b128 v[116:119], v132 offset:80
    s_waitcnt lgkmcnt(10)
    v_mfma_f32_16x16x32_bf16 v[248:251], v[72:75], v[40:43], v[248:251]
    ds_read_b128 v[56:59], v130 offset:96
    ds_read_b128 v[88:91], v131 offset:96
    s_waitcnt lgkmcnt(11)
    v_mfma_f32_16x16x32_bf16 v[252:255], v[104:107], v[40:43], v[252:255]
    ds_read_b128 v[120:123], v132 offset:96
    s_waitcnt lgkmcnt(10)
    v_mfma_f32_16x16x32_bf16 v[248:251], v[76:79], v[44:47], v[248:251]
    ds_read_b128 v[60:63], v130 offset:112
    ds_read_b128 v[92:95], v131 offset:112
    s_waitcnt lgkmcnt(11)
    v_mfma_f32_16x16x32_bf16 v[252:255], v[108:111], v[44:47], v[252:255]
    ds_read_b128 v[124:127], v132 offset:112
    s_waitcnt lgkmcnt(10)
    v_mfma_f32_16x16x32_bf16 v[248:251], v[80:83], v[48:51], v[248:251]
    s_waitcnt lgkmcnt(9)
    v_mfma_f32_16x16x32_bf16 v[252:255], v[112:115], v[48:51], v[252:255]
    s_waitcnt lgkmcnt(7)
    v_mfma_f32_16x16x32_bf16 v[248:251], v[84:87], v[52:55], v[248:251]
    s_waitcnt lgkmcnt(6)
    v_mfma_f32_16x16x32_bf16 v[252:255], v[116:119], v[52:55], v[252:255]
    s_waitcnt lgkmcnt(4)
    v_mfma_f32_16x16x32_bf16 v[248:251], v[88:91], v[56:59], v[248:251]
    s_waitcnt lgkmcnt(3)
    v_mfma_f32_16x16x32_bf16 v[252:255], v[120:123], v[56:59], v[252:255]
    s_waitcnt lgkmcnt(1)
    v_mfma_f32_16x16x32_bf16 v[248:251], v[92:95], v[60:63], v[248:251]
    s_waitcnt lgkmcnt(0)
    v_mfma_f32_16x16x32_bf16 v[252:255], v[124:127], v[60:63], v[252:255]
    s_nop 7
    v_permlane16_swap_b32 v248, v252
    v_permlane16_swap_b32 v249, v253
    v_permlane16_swap_b32 v250, v254
    v_permlane16_swap_b32 v251, v255
    v_cvt_pk_bf16_f32 v24, v255, v254
    v_cvt_pk_bf16_f32 v25, v253, v252
    v_cvt_pk_bf16_f32 v26, v251, v250
    v_cvt_pk_bf16_f32 v27, v249, v248
    ds_write_b128 v5, v[24:27]
    v_cvt_pk_bf16_f32 v28, v254, v253
    v_cvt_pk_bf16_f32 v29, v252, v251
    v_cvt_pk_bf16_f32 v30, v250, v249
    ds_write_b16 v5, v24 offset:1214
    ds_write_b16_d16_hi v5, v27 offset:1228
    ds_write_b96 v5, v[28:30] offset:1216
    s_waitcnt vmcnt(0)
    v_perm_b32 v156, v142, v140, v154
    v_perm_b32 v157, v146, v144, v154
    ds_write_b32 v148, v156 offset:0
    ds_write_b32 v149, v157 offset:0
    v_perm_b32 v158, v142, v140, v155
    v_perm_b32 v159, v146, v144, v155
    ds_write_b32 v148, v158 offset:4608
    ds_write_b32 v149, v159 offset:4608
    v_perm_b32 v160, v143, v141, v154
    v_perm_b32 v161, v147, v145, v154
    ds_write_b32 v148, v160 offset:9216
    ds_write_b32 v149, v161 offset:9216
    v_perm_b32 v162, v143, v141, v155
    v_perm_b32 v163, v147, v145, v155
    ds_write_b32 v148, v162 offset:13824
    ds_write_b32 v149, v163 offset:13824
    s_add_u32 s48, s50, 2
    v_add_u32 v8, s48, v6
    s_waitcnt lgkmcnt(0)
    s_barrier
    s_setprio 1
    ds_read2_b32 v[104:105], v8 offset0:247 offset1:248
    ds_read2_b32 v[106:107], v8 offset0:249 offset1:250
    ds_read2_b32 v[108:109], v8 offset0:119 offset1:120
    ds_read2_b32 v[110:111], v8 offset0:121 offset1:122
    ds_read_b128 v[72:75], v7 offset:416
    ds_read_b128 v[76:79], v7 offset:928
    ds_read_b128 v[80:83], v7 offset:1440
    ds_read_b128 v[84:87], v7 offset:1952
    ds_read_b128 v[88:91], v7 offset:2464
    ds_read_b128 v[92:95], v7 offset:2976
    ds_read_b128 v[96:99], v7 offset:3488
    ds_read_b128 v[100:103], v7 offset:4000
    ds_read2_b32 v[144:145], v8 offset0:231 offset1:232
    ds_read2_b32 v[146:147], v8 offset0:233 offset1:234
    s_waitcnt lgkmcnt(2)
    v_mfma_f32_16x16x32_bf16 v[220:223], v[104:107], v[72:75], 0
    ds_read2_b32 v[148:149], v8 offset0:103 offset1:104
    v_mfma_f32_16x16x32_bf16 v[224:227], v[104:107], v[76:79], 0
    ds_read2_b32 v[150:151], v8 offset0:105 offset1:106
    v_mfma_f32_16x16x32_bf16 v[228:231], v[104:107], v[80:83], 0
    ds_read_b128 v[112:115], v7 offset:352
    v_mfma_f32_16x16x32_bf16 v[232:235], v[104:107], v[84:87], 0
    ds_read_b128 v[116:119], v7 offset:864
    v_mfma_f32_16x16x32_bf16 v[204:207], v[104:107], v[88:91], 0
    ds_read_b128 v[120:123], v7 offset:1376
    v_mfma_f32_16x16x32_bf16 v[208:211], v[104:107], v[92:95], 0
    ds_read_b128 v[124:127], v7 offset:1888
    v_mfma_f32_16x16x32_bf16 v[212:215], v[104:107], v[96:99], 0
    ds_read_b128 v[128:131], v7 offset:2400
    v_mfma_f32_16x16x32_bf16 v[216:219], v[104:107], v[100:103], 0
    ds_read_b128 v[132:135], v7 offset:2912
    v_mfma_f32_16x16x32_bf16 v[224:227], v[108:111], v[72:75], v[224:227]
    ds_read_b128 v[136:139], v7 offset:3424
    v_mfma_f32_16x16x32_bf16 v[228:231], v[108:111], v[76:79], v[228:231]
    ds_read_b128 v[140:143], v7 offset:3936
    v_mfma_f32_16x16x32_bf16 v[232:235], v[108:111], v[80:83], v[232:235]
    ds_read2_b32 v[64:65], v8 offset0:215 offset1:216
    v_mfma_f32_16x16x32_bf16 v[204:207], v[108:111], v[84:87], v[204:207]
    ds_read2_b32 v[66:67], v8 offset0:217 offset1:218
    v_mfma_f32_16x16x32_bf16 v[208:211], v[108:111], v[88:91], v[208:211]
    v_mfma_f32_16x16x32_bf16 v[212:215], v[108:111], v[92:95], v[212:215]
    v_mfma_f32_16x16x32_bf16 v[216:219], v[108:111], v[96:99], v[216:219]
    s_waitcnt lgkmcnt(2)
    v_mfma_f32_16x16x32_bf16 v[220:223], v[144:147], v[112:115], v[220:223]
    ds_read2_b32 v[68:69], v8 offset0:87 offset1:88
    v_mfma_f32_16x16x32_bf16 v[224:227], v[144:147], v[116:119], v[224:227]
    ds_read2_b32 v[70:71], v8 offset0:89 offset1:90
    v_mfma_f32_16x16x32_bf16 v[228:231], v[144:147], v[120:123], v[228:231]
    ds_read_b128 v[32:35], v7 offset:288
    v_mfma_f32_16x16x32_bf16 v[232:235], v[144:147], v[124:127], v[232:235]
    ds_read_b128 v[36:39], v7 offset:800
    v_mfma_f32_16x16x32_bf16 v[204:207], v[144:147], v[128:131], v[204:207]
    ds_read_b128 v[40:43], v7 offset:1312
    v_mfma_f32_16x16x32_bf16 v[208:211], v[144:147], v[132:135], v[208:211]
    ds_read_b128 v[44:47], v7 offset:1824
    v_mfma_f32_16x16x32_bf16 v[212:215], v[144:147], v[136:139], v[212:215]
    ds_read_b128 v[48:51], v7 offset:2336
    v_mfma_f32_16x16x32_bf16 v[216:219], v[144:147], v[140:143], v[216:219]
    ds_read_b128 v[52:55], v7 offset:2848
    v_mfma_f32_16x16x32_bf16 v[224:227], v[148:151], v[112:115], v[224:227]
    ds_read_b128 v[56:59], v7 offset:3360
    v_mfma_f32_16x16x32_bf16 v[228:231], v[148:151], v[116:119], v[228:231]
    ds_read_b128 v[60:63], v7 offset:3872
    v_mfma_f32_16x16x32_bf16 v[232:235], v[148:151], v[120:123], v[232:235]
    ds_read2_b32 v[104:105], v8 offset0:199 offset1:200
    v_mfma_f32_16x16x32_bf16 v[204:207], v[148:151], v[124:127], v[204:207]
    ds_read2_b32 v[106:107], v8 offset0:201 offset1:202
    v_mfma_f32_16x16x32_bf16 v[208:211], v[148:151], v[128:131], v[208:211]
    v_mfma_f32_16x16x32_bf16 v[212:215], v[148:151], v[132:135], v[212:215]
    v_mfma_f32_16x16x32_bf16 v[216:219], v[148:151], v[136:139], v[216:219]
    s_waitcnt lgkmcnt(2)
    v_mfma_f32_16x16x32_bf16 v[220:223], v[64:67], v[32:35], v[220:223]
    ds_read2_b32 v[108:109], v8 offset0:71 offset1:72
    v_mfma_f32_16x16x32_bf16 v[224:227], v[64:67], v[36:39], v[224:227]
    ds_read2_b32 v[110:111], v8 offset0:73 offset1:74
    v_mfma_f32_16x16x32_bf16 v[228:231], v[64:67], v[40:43], v[228:231]
    ds_read_b128 v[72:75], v7 offset:224
    v_mfma_f32_16x16x32_bf16 v[232:235], v[64:67], v[44:47], v[232:235]
    ds_read_b128 v[76:79], v7 offset:736
    v_mfma_f32_16x16x32_bf16 v[204:207], v[64:67], v[48:51], v[204:207]
    ds_read_b128 v[80:83], v7 offset:1248
    v_mfma_f32_16x16x32_bf16 v[208:211], v[64:67], v[52:55], v[208:211]
    ds_read_b128 v[84:87], v7 offset:1760
    v_mfma_f32_16x16x32_bf16 v[212:215], v[64:67], v[56:59], v[212:215]
    ds_read_b128 v[88:91], v7 offset:2272
    v_mfma_f32_16x16x32_bf16 v[216:219], v[64:67], v[60:63], v[216:219]
    ds_read_b128 v[92:95], v7 offset:2784
    v_mfma_f32_16x16x32_bf16 v[224:227], v[68:71], v[32:35], v[224:227]
    ds_read_b128 v[96:99], v7 offset:3296
    v_mfma_f32_16x16x32_bf16 v[228:231], v[68:71], v[36:39], v[228:231]
    ds_read_b128 v[100:103], v7 offset:3808
    v_mfma_f32_16x16x32_bf16 v[232:235], v[68:71], v[40:43], v[232:235]
    ds_read2_b32 v[144:145], v8 offset0:183 offset1:184
    v_mfma_f32_16x16x32_bf16 v[204:207], v[68:71], v[44:47], v[204:207]
    ds_read2_b32 v[146:147], v8 offset0:185 offset1:186
    v_mfma_f32_16x16x32_bf16 v[208:211], v[68:71], v[48:51], v[208:211]
    v_mfma_f32_16x16x32_bf16 v[212:215], v[68:71], v[52:55], v[212:215]
    v_mfma_f32_16x16x32_bf16 v[216:219], v[68:71], v[56:59], v[216:219]
    s_setprio 0
    s_waitcnt lgkmcnt(2)
    v_mfma_f32_16x16x32_bf16 v[220:223], v[104:107], v[72:75], v[220:223]
    ds_read2_b32 v[148:149], v8 offset0:55 offset1:56
    v_mfma_f32_16x16x32_bf16 v[224:227], v[104:107], v[76:79], v[224:227]
    ds_read2_b32 v[150:151], v8 offset0:57 offset1:58
    v_mfma_f32_16x16x32_bf16 v[228:231], v[104:107], v[80:83], v[228:231]
    ds_read_b128 v[112:115], v7 offset:160
    v_mfma_f32_16x16x32_bf16 v[232:235], v[104:107], v[84:87], v[232:235]
    ds_read_b128 v[116:119], v7 offset:672
    v_mfma_f32_16x16x32_bf16 v[204:207], v[104:107], v[88:91], v[204:207]
    ds_read_b128 v[120:123], v7 offset:1184
    v_mfma_f32_16x16x32_bf16 v[208:211], v[104:107], v[92:95], v[208:211]
    ds_read_b128 v[124:127], v7 offset:1696
    v_mfma_f32_16x16x32_bf16 v[212:215], v[104:107], v[96:99], v[212:215]
    ds_read_b128 v[128:131], v7 offset:2208
    v_mfma_f32_16x16x32_bf16 v[216:219], v[104:107], v[100:103], v[216:219]
    ds_read_b128 v[132:135], v7 offset:2720
    v_mfma_f32_16x16x32_bf16 v[224:227], v[108:111], v[72:75], v[224:227]
    ds_read_b128 v[136:139], v7 offset:3232
    v_mfma_f32_16x16x32_bf16 v[228:231], v[108:111], v[76:79], v[228:231]
    ds_read_b128 v[140:143], v7 offset:3744
    v_mfma_f32_16x16x32_bf16 v[232:235], v[108:111], v[80:83], v[232:235]
    ds_read2_b32 v[64:65], v8 offset0:167 offset1:168
    v_mfma_f32_16x16x32_bf16 v[204:207], v[108:111], v[84:87], v[204:207]
    ds_read2_b32 v[66:67], v8 offset0:169 offset1:170
    v_mfma_f32_16x16x32_bf16 v[208:211], v[108:111], v[88:91], v[208:211]
    v_mfma_f32_16x16x32_bf16 v[212:215], v[108:111], v[92:95], v[212:215]
    v_mfma_f32_16x16x32_bf16 v[216:219], v[108:111], v[96:99], v[216:219]
    s_waitcnt lgkmcnt(2)
    v_mfma_f32_16x16x32_bf16 v[220:223], v[144:147], v[112:115], v[220:223]
    ds_read2_b32 v[68:69], v8 offset0:39 offset1:40
    v_mfma_f32_16x16x32_bf16 v[224:227], v[144:147], v[116:119], v[224:227]
    ds_read2_b32 v[70:71], v8 offset0:41 offset1:42
    v_mfma_f32_16x16x32_bf16 v[228:231], v[144:147], v[120:123], v[228:231]
    ds_read_b128 v[32:35], v7 offset:96
    v_mfma_f32_16x16x32_bf16 v[232:235], v[144:147], v[124:127], v[232:235]
    ds_read_b128 v[36:39], v7 offset:608
    v_mfma_f32_16x16x32_bf16 v[204:207], v[144:147], v[128:131], v[204:207]
    ds_read_b128 v[40:43], v7 offset:1120
    v_mfma_f32_16x16x32_bf16 v[208:211], v[144:147], v[132:135], v[208:211]
    ds_read_b128 v[44:47], v7 offset:1632
    v_mfma_f32_16x16x32_bf16 v[212:215], v[144:147], v[136:139], v[212:215]
    ds_read_b128 v[48:51], v7 offset:2144
    v_mfma_f32_16x16x32_bf16 v[216:219], v[144:147], v[140:143], v[216:219]
    ds_read_b128 v[52:55], v7 offset:2656
    v_mfma_f32_16x16x32_bf16 v[224:227], v[148:151], v[112:115], v[224:227]
    ds_read_b128 v[56:59], v7 offset:3168
    v_mfma_f32_16x16x32_bf16 v[228:231], v[148:151], v[116:119], v[228:231]
    ds_read_b128 v[60:63], v7 offset:3680
    v_mfma_f32_16x16x32_bf16 v[232:235], v[148:151], v[120:123], v[232:235]
    ds_read2_b32 v[104:105], v8 offset0:151 offset1:152
    v_mfma_f32_16x16x32_bf16 v[204:207], v[148:151], v[124:127], v[204:207]
    ds_read2_b32 v[106:107], v8 offset0:153 offset1:154
    v_mfma_f32_16x16x32_bf16 v[208:211], v[148:151], v[128:131], v[208:211]
    v_mfma_f32_16x16x32_bf16 v[212:215], v[148:151], v[132:135], v[212:215]
    v_mfma_f32_16x16x32_bf16 v[216:219], v[148:151], v[136:139], v[216:219]
    s_waitcnt lgkmcnt(2)
    v_mfma_f32_16x16x32_bf16 v[220:223], v[64:67], v[32:35], v[220:223]
    ds_read2_b32 v[108:109], v8 offset0:23 offset1:24
    v_mfma_f32_16x16x32_bf16 v[224:227], v[64:67], v[36:39], v[224:227]
    ds_read2_b32 v[110:111], v8 offset0:25 offset1:26
    v_mfma_f32_16x16x32_bf16 v[228:231], v[64:67], v[40:43], v[228:231]
    ds_read_b128 v[72:75], v7 offset:32
    v_mfma_f32_16x16x32_bf16 v[232:235], v[64:67], v[44:47], v[232:235]
    ds_read_b128 v[76:79], v7 offset:544
    v_mfma_f32_16x16x32_bf16 v[204:207], v[64:67], v[48:51], v[204:207]
    ds_read_b128 v[80:83], v7 offset:1056
    v_mfma_f32_16x16x32_bf16 v[208:211], v[64:67], v[52:55], v[208:211]
    ds_read_b128 v[84:87], v7 offset:1568
    v_mfma_f32_16x16x32_bf16 v[212:215], v[64:67], v[56:59], v[212:215]
    ds_read_b128 v[88:91], v7 offset:2080
    v_mfma_f32_16x16x32_bf16 v[216:219], v[64:67], v[60:63], v[216:219]
    ds_read_b128 v[92:95], v7 offset:2592
    v_mfma_f32_16x16x32_bf16 v[224:227], v[68:71], v[32:35], v[224:227]
    ds_read_b128 v[96:99], v7 offset:3104
    v_mfma_f32_16x16x32_bf16 v[228:231], v[68:71], v[36:39], v[228:231]
    ds_read_b128 v[100:103], v7 offset:3616
    v_mfma_f32_16x16x32_bf16 v[232:235], v[68:71], v[40:43], v[232:235]
    v_mfma_f32_16x16x32_bf16 v[204:207], v[68:71], v[44:47], v[204:207]
    v_mfma_f32_16x16x32_bf16 v[208:211], v[68:71], v[48:51], v[208:211]
    v_mfma_f32_16x16x32_bf16 v[212:215], v[68:71], v[52:55], v[212:215]
    v_mfma_f32_16x16x32_bf16 v[216:219], v[68:71], v[56:59], v[216:219]
    s_waitcnt lgkmcnt(0)
    v_mfma_f32_16x16x32_bf16 v[220:223], v[104:107], v[72:75], v[220:223]
    v_mfma_f32_16x16x32_bf16 v[224:227], v[104:107], v[76:79], v[224:227]
    v_mfma_f32_16x16x32_bf16 v[228:231], v[104:107], v[80:83], v[228:231]
    v_mfma_f32_16x16x32_bf16 v[232:235], v[104:107], v[84:87], v[232:235]
    v_mfma_f32_16x16x32_bf16 v[204:207], v[104:107], v[88:91], v[204:207]
    v_mfma_f32_16x16x32_bf16 v[208:211], v[104:107], v[92:95], v[208:211]
    v_mfma_f32_16x16x32_bf16 v[212:215], v[104:107], v[96:99], v[212:215]
    v_mfma_f32_16x16x32_bf16 v[216:219], v[104:107], v[100:103], v[216:219]
    v_mfma_f32_16x16x32_bf16 v[224:227], v[108:111], v[72:75], v[224:227]
    v_mfma_f32_16x16x32_bf16 v[228:231], v[108:111], v[76:79], v[228:231]
    v_mfma_f32_16x16x32_bf16 v[232:235], v[108:111], v[80:83], v[232:235]
    v_mfma_f32_16x16x32_bf16 v[204:207], v[108:111], v[84:87], v[204:207]
    v_mfma_f32_16x16x32_bf16 v[208:211], v[108:111], v[88:91], v[208:211]
    v_mfma_f32_16x16x32_bf16 v[212:215], v[108:111], v[92:95], v[212:215]
    v_mfma_f32_16x16x32_bf16 v[216:219], v[108:111], v[96:99], v[216:219]
    s_nop 7
B_epi:
    s_lshl_b32 s51, s44, 13
    s_lshl_b32 s48, s45, 12
    s_add_u32 s6, s51, s48
    v_lshl_add_u32 v6, v1, 4, s6
    ds_write_b128 v6, v[220:223] offset:0
    ds_write_b128 v6, v[224:227] offset:1024
    ds_write_b128 v6, v[228:231] offset:2048
    ds_write_b128 v6, v[232:235] offset:3072
    v_xor_b32 v6, 4096, v6
    s_lshl_b32 s48, s45, 11
    s_lshl_b32 s51, s47, 12
    s_add_u32 s51, s51, s48
    s_add_u32 s51, s51, 2097152
    s_add_u32 s68, s42, s51
    s_addc_u32 s69, s43, 0
    s_waitcnt lgkmcnt(0)
    s_barrier
    ds_read_b128 v[48:51], v6 offset:0
    ds_read_b128 v[52:55], v6 offset:1024
    ds_read_b128 v[56:59], v6 offset:2048
    ds_read_b128 v[60:63], v6 offset:3072
    v_and_b32 v22, 1, v3
    v_mul_u32_u24 v22, 504, v22
    v_add_u32 v22, v22, v4
    s_waitcnt lgkmcnt(3)
    v_pk_add_f32 v[204:205], v[204:205], v[48:49]
    v_pk_add_f32 v[206:207], v[206:207], v[50:51]
    v_cvt_pk_bf16_f32 v64, v204, v205
    v_cvt_pk_bf16_f32 v65, v206, v207
    s_waitcnt lgkmcnt(2)
    v_pk_add_f32 v[208:209], v[208:209], v[52:53]
    v_pk_add_f32 v[210:211], v[210:211], v[54:55]
    v_cvt_pk_bf16_f32 v66, v208, v209
    v_cvt_pk_bf16_f32 v67, v210, v211
    s_nop 0
    v_permlane16_swap_b32 v64, v66
    v_permlane16_swap_b32 v65, v67
    global_store_dwordx4 v22, v[64:67], s[68:69] offset:0 sc0 sc1
    s_waitcnt lgkmcnt(1)
    v_pk_add_f32 v[212:213], v[212:213], v[56:57]
    v_pk_add_f32 v[214:215], v[214:215], v[58:59]
    v_cvt_pk_bf16_f32 v68, v212, v213
    v_cvt_pk_bf16_f32 v69, v214, v215
    s_waitcnt lgkmcnt(0)
    v_pk_add_f32 v[216:217], v[216:217], v[60:61]
    v_pk_add_f32 v[218:219], v[218:219], v[62:63]
    v_cvt_pk_bf16_f32 v70, v216, v217
    v_cvt_pk_bf16_f32 v71, v218, v219
    s_nop 0
    v_permlane16_swap_b32 v68, v70
    v_permlane16_swap_b32 v69, v71
    global_store_dwordx4 v22, v[68:71], s[68:69] offset:1024 sc0 sc1
    s_endpgm
    s_nop 0
K1_exit:
    s_endpgm
.globl k2_kernel
.p2align 8
.type k2_kernel,@function
k2_kernel:
    s_cmp_ge_u32 s2, 256
    s_cbranch_scc1 K2_exit
    s_load_dwordx2 s[20:21], s[0:1], 16
    s_load_dwordx2 s[38:39], s[0:1], 88
    s_load_dwordx2 s[42:43], s[0:1], 104
    v_lshrrev_b32 v1, 6, v0
    s_and_b32 s46, s2, 7
    v_readfirstlane_b32 s5, v1
    s_lshl_b32 s44, s46, 2
    s_bfe_u32 s46, s2, 0x20003
    s_add_u32 s44, s44, s46
    s_lshr_b32 s45, s2, 5
    v_and_b32 v1, 63, v0
    s_lshr_b32 s48, s5, 1
    s_and_b32 s49, s5, 1
    v_lshlrev_b32 v10, 4, v1
    v_lshrrev_b32 v3, 5, v1
    v_mul_u32_u24 v4, 4352, v3
    v_and_b32 v2, 31, v1
    v_lshl_add_u32 v15, v2, 3, v4
    v_add_u32 v15, 4096, v15
    v_lshrrev_b32 v2, 3, v1
    v_and_b32 v4, 7, v1
    v_bfe_u32 v5, v1, 4, 1
    v_lshlrev_b32 v5, 2, v5
    v_xor_b32 v4, v4, v5
    v_lshlrev_b32 v4, 4, v4
    v_lshl_add_u32 v12, v2, 10, v4
    s_lshl_b32 s46, s48, 15
    v_add_u32 v248, s46, v10
    v_xor_b32 v249, 0x8000, v248
    s_mul_i32 s46, s5, 8704
    s_add_u32 s46, s46, 4194304
    s_lshl_b32 s6, s44, 16
    s_lshl_b32 s47, s5, 13
    s_add_u32 s6, s6, s47
    s_lshl_b32 s50, s5, 17
    s_lshl_b32 s47, s45, 7
    s_add_u32 s50, s50, s47
    s_add_u32 s7, s45, 0
    s_and_b32 s7, s7, 7
    s_lshl_b32 s47, s7, 10
    s_add_u32 s24, s6, s47
    s_add_u32 s8, s46, s47
    s_lshl_b32 s47, s7, 14
    s_add_u32 s80, s50, s47
    s_lshr_b32 s7, s7, 2
    s_lshl_b32 s7, s7, 8
    s_add_u32 s8, s8, s7
    s_add_u32 s7, s45, 1
    s_and_b32 s7, s7, 7
    s_lshl_b32 s47, s7, 10
    s_add_u32 s25, s6, s47
    s_add_u32 s9, s46, s47
    s_lshl_b32 s47, s7, 14
    s_add_u32 s81, s50, s47
    s_lshr_b32 s7, s7, 2
    s_lshl_b32 s7, s7, 8
    s_add_u32 s9, s9, s7
    s_add_u32 s7, s45, 2
    s_and_b32 s7, s7, 7
    s_lshl_b32 s47, s7, 10
    s_add_u32 s26, s6, s47
    s_add_u32 s10, s46, s47
    s_lshl_b32 s47, s7, 14
    s_add_u32 s82, s50, s47
    s_lshr_b32 s7, s7, 2
    s_lshl_b32 s7, s7, 8
    s_add_u32 s10, s10, s7
    s_add_u32 s7, s45, 3
    s_and_b32 s7, s7, 7
    s_lshl_b32 s47, s7, 10
    s_add_u32 s27, s6, s47
    s_add_u32 s11, s46, s47
    s_lshl_b32 s47, s7, 14
    s_add_u32 s83, s50, s47
    s_lshr_b32 s7, s7, 2
    s_lshl_b32 s7, s7, 8
    s_add_u32 s11, s11, s7
    s_add_u32 s7, s45, 4
    s_and_b32 s7, s7, 7
    s_lshl_b32 s47, s7, 10
    s_add_u32 s28, s6, s47
    s_add_u32 s12, s46, s47
    s_lshl_b32 s47, s7, 14
    s_add_u32 s84, s50, s47
    s_lshr_b32 s7, s7, 2
    s_lshl_b32 s7, s7, 8
    s_add_u32 s12, s12, s7
    s_add_u32 s7, s45, 5
    s_and_b32 s7, s7, 7
    s_lshl_b32 s47, s7, 10
    s_add_u32 s29, s6, s47
    s_add_u32 s13, s46, s47
    s_lshl_b32 s47, s7, 14
    s_add_u32 s85, s50, s47
    s_lshr_b32 s7, s7, 2
    s_lshl_b32 s7, s7, 8
    s_add_u32 s13, s13, s7
    s_add_u32 s7, s45, 6
    s_and_b32 s7, s7, 7
    s_lshl_b32 s47, s7, 10
    s_add_u32 s30, s6, s47
    s_add_u32 s14, s46, s47
    s_lshl_b32 s47, s7, 14
    s_add_u32 s86, s50, s47
    s_lshr_b32 s7, s7, 2
    s_lshl_b32 s7, s7, 8
    s_add_u32 s14, s14, s7
    s_add_u32 s7, s45, 7
    s_and_b32 s7, s7, 7
    s_lshl_b32 s47, s7, 10
    s_add_u32 s31, s6, s47
    s_add_u32 s15, s46, s47
    s_lshl_b32 s47, s7, 14
    s_add_u32 s87, s50, s47
    s_lshr_b32 s7, s7, 2
    s_lshl_b32 s7, s7, 8
    s_add_u32 s15, s15, s7
    s_mov_b32 s7, s46
    s_lshl_b32 m0, s5, 14
    s_mov_b32 s54, 0x80000
    s_mov_b32 s55, 0x00020000
    s_mov_b32 s62, 0x420000
    s_mov_b32 s63, 0x00020000
    v_add_u32 v11, 8192, v12
    s_waitcnt lgkmcnt(0)
    s_mov_b32 s60, s42
    s_mov_b32 s61, s43
    s_mov_b32 s52, s20
    s_mov_b32 s53, s21
    v_mov_b32 v7, v11
    buffer_load_dwordx2 v[250:251], v15, s[60:63], s7 offen
    buffer_load_dwordx4 v[16:19], v10, s[60:63], s8 offen
    buffer_load_dwordx4 v[24:27], v10, s[60:63], s9 offen
    buffer_load_dwordx4 v[80:83], v248, s[60:63], s24 offen
    buffer_load_dwordx4 v[84:87], v249, s[60:63], s24 offen
    buffer_load_dwordx4 v12, s[52:55], s80 offen lds
    s_add_u32 m0, m0, 1024
    s_nop 0
    buffer_load_dwordx4 v7, s[52:55], s80 offen lds
    s_add_u32 m0, m0, 1024
    buffer_load_dwordx4 v[88:91], v248, s[60:63], s25 offen
    buffer_load_dwordx4 v[92:95], v249, s[60:63], s25 offen
    buffer_load_dwordx4 v12, s[52:55], s81 offen lds
    s_add_u32 m0, m0, 1024
    s_nop 0
    buffer_load_dwordx4 v7, s[52:55], s81 offen lds
    s_add_u32 m0, m0, 1024
    buffer_load_dwordx4 v[32:35], v10, s[60:63], s10 offen
    buffer_load_dwordx4 v[40:43], v10, s[60:63], s11 offen
    buffer_load_dwordx4 v[96:99], v248, s[60:63], s26 offen
    buffer_load_dwordx4 v[100:103], v249, s[60:63], s26 offen
    buffer_load_dwordx4 v12, s[52:55], s82 offen lds
    s_add_u32 m0, m0, 1024
    s_nop 0
    buffer_load_dwordx4 v7, s[52:55], s82 offen lds
    s_add_u32 m0, m0, 1024
    s_lshl_b32 s46, s5, 8
    s_add_u32 s46, s46, 122880
    s_lshl_b32 s47, s45, 3
    v_subrev_u32 v252, s47, v1
    v_and_b32 v252, 63, v252
    v_lshl_add_u32 v252, v252, 2, s46
    v_lshrrev_b32 v253, 4, v1
    v_lshl_add_u32 v253, v253, 3, s46
    v_bfe_u32 v2, v1, 2, 2
    v_lshrrev_b32 v3, 5, v1
    v_lshl_add_u32 v2, v3, 2, v2
    v_lshlrev_b32 v2, 7, v2
    v_and_b32 v3, 1, v1
    v_bfe_u32 v4, v1, 4, 1
    v_lshl_add_u32 v3, v3, 1, v4
    v_bfe_u32 v4, v1, 3, 1
    v_xor_b32 v4, s49, v4
    v_lshl_add_u32 v3, v4, 2, v3
    v_lshl_add_u32 v2, v3, 4, v2
    v_bfe_u32 v4, v1, 1, 1
    v_lshl_add_u32 v2, v4, 3, v2
    s_lshl_b32 s46, s5, 14
    v_add_u32 v13, s46, v2
    v_xor_b32 v8, 64, v13
    s_mov_b32 s64, 0x358637bd
    v_lshrrev_b32 v2, 2, v1
    v_and_b32 v4, 3, v1
    v_lshlrev_b32 v4, 4, v4
    v_lshl_add_u32 v14, v2, 12, v4
    s_add_u32 s56, s42, 2097152
    s_addc_u32 s57, s43, 0
    s_mov_b32 s58, 0x200000
    s_mov_b32 s59, 0x00020000
    s_lshl_b32 s66, s45, 18
    s_lshl_b32 s47, s49, 17
    s_add_u32 s66, s66, s47
    s_lshl_b32 s47, s44, 7
    s_add_u32 s66, s66, s47
    s_lshl_b32 s47, s48, 6
    s_add_u32 s66, s66, s47
    s_lshl_b32 s67, s44, 8
    s_lshl_b32 s47, s48, 7
    s_add_u32 s67, s67, s47
    s_add_u32 s67, s67, 4259840
    v_and_b32 v9, 31, v1
    v_lshl_add_u32 v9, v9, 2, s67
    s_xor_b32 s46, s5, 1
    s_mul_i32 s46, s46, 12288
    s_add_u32 s46, s46, 73728
    v_add_u32 v3, s46, v10
    s_xor_b32 s46, s5, 2
    s_mul_i32 s46, s46, 12288
    s_add_u32 s46, s46, 73728
    v_add_u32 v4, s46, v10
    s_xor_b32 s46, s5, 3
    s_mul_i32 s46, s46, 12288
    s_add_u32 s46, s46, 73728
    v_add_u32 v5, s46, v10
    v_bfe_u32 v2, v1, 2, 2
    v_lshrrev_b32 v11, 5, v1
    v_lshl_add_u32 v2, v11, 4, v2
    v_lshlrev_b32 v2, 6, v2
    v_bfe_u32 v6, v1, 4, 1
    v_lshl_add_u32 v2, v6, 5, v2
    v_and_b32 v6, 3, v1
    v_lshl_add_u32 v2, v6, 3, v2
    s_lshl_b32 s46, s5, 11
    s_add_u32 s46, s46, 65536
    v_add_u32 v2, s46, v2
    s_mul_i32 s46, s5, 12288
    s_add_u32 s46, s46, 73728
    v_add_u32 v6, s46, v10
    v_and_b32 v15, 31, v1
    v_lshlrev_b32 v11, 5, v11
    v_lshl_add_u32 v15, v15, 10, v11
    s_lshl_b32 s46, s44, 16
    s_lshl_b32 s47, s48, 15
    s_add_u32 s46, s46, s47
    s_lshl_b32 s47, s45, 7
    s_add_u32 s46, s46, s47
    s_lshl_b32 s47, s49, 6
    s_add_u32 s46, s46, s47
    v_add_u32 v15, s46, v15
    s_waitcnt vmcnt(16)
    v_cvt_pk_bf16_f32 v250, v250, v251
    ds_write_b32 v252, v250
    ds_read_b64 v[250:251], v253 offset:0
    s_waitcnt vmcnt(10)
    v_cvt_pk_bf16_f32 v16, v16, v17
    v_cvt_pk_bf16_f32 v17, v18, v19
    s_waitcnt lgkmcnt(0)
    v_mov_b32 v18, v250
    v_mov_b32 v19, v251
    ds_read_b64_tr_b16 v[20:21], v13 offset:0
    ds_read_b64_tr_b16 v[22:23], v13 offset:1024
    v_permlane16_swap_b32 v16, v18
    v_permlane16_swap_b32 v17, v19
    ds_read_b64 v[254:255], v253 offset:32
    s_nop 0
    v_mfma_f32_32x32x16_bf16 v[208:223], v[16:19], v[80:83], 0
    buffer_load_dwordx4 v[48:51], v10, s[60:63], s12 offen
    buffer_load_dwordx4 v[104:107], v248, s[60:63], s27 offen
    buffer_load_dwordx4 v[108:111], v249, s[60:63], s27 offen
    buffer_load_dwordx4 v12, s[52:55], s83 offen lds
    s_add_u32 m0, m0, 1024
    v_mfma_f32_32x32x16_bf16 v[224:239], v[16:19], v[84:87], 0
    s_nop 0
    buffer_load_dwordx4 v7, s[52:55], s83 offen lds
    s_add_u32 m0, m0, 1024
    ds_read_b64_tr_b16 v[240:241], v8 offset:0
    ds_read_b64_tr_b16 v[242:243], v8 offset:1024
    s_nop 0
    v_add_f32 v216, s64, v216
    v_rcp_f32 v216, v216
    s_nop 0
    v_mul_f32 v208, v208, v216
    v_mul_f32 v209, v209, v216
    v_mul_f32 v210, v210, v216
    v_mul_f32 v211, v211, v216
    v_mul_f32 v212, v212, v216
    v_mul_f32 v213, v213, v216
    v_mul_f32 v214, v214, v216
    v_mul_f32 v215, v215, v216
    v_cvt_pk_bf16_f32 v80, v208, v209
    v_cvt_pk_bf16_f32 v81, v210, v211
    v_cvt_pk_bf16_f32 v82, v212, v213
    v_cvt_pk_bf16_f32 v83, v214, v215
    v_add_f32 v232, s64, v232
    v_rcp_f32 v232, v232
    s_nop 0
    v_mul_f32 v224, v224, v232
    v_mul_f32 v225, v225, v232
    v_mul_f32 v226, v226, v232
    v_mul_f32 v227, v227, v232
    v_mul_f32 v228, v228, v232
    v_mul_f32 v229, v229, v232
    v_mul_f32 v230, v230, v232
    v_mul_f32 v231, v231, v232
    v_cvt_pk_bf16_f32 v84, v224, v225
    v_cvt_pk_bf16_f32 v85, v226, v227
    v_cvt_pk_bf16_f32 v86, v228, v229
    v_cvt_pk_bf16_f32 v87, v230, v231
    s_waitcnt vmcnt(11)
    v_cvt_pk_bf16_f32 v24, v24, v25
    v_cvt_pk_bf16_f32 v25, v26, v27
    s_waitcnt lgkmcnt(2)
    v_mov_b32 v26, v254
    v_mov_b32 v27, v255
    ds_read_b64_tr_b16 v[28:29], v13 offset:2048
    ds_read_b64_tr_b16 v[30:31], v13 offset:3072
    v_permlane16_swap_b32 v24, v26
    v_permlane16_swap_b32 v25, v27
    ds_read_b64 v[250:251], v253 offset:64
    s_nop 0
    v_mfma_f32_32x32x16_bf16 v[208:223], v[24:27], v[88:91], 0
    buffer_load_dwordx4 v[56:59], v10, s[60:63], s13 offen
    buffer_load_dwordx4 v[112:115], v248, s[60:63], s28 offen
    buffer_load_dwordx4 v[116:119], v249, s[60:63], s28 offen
    buffer_load_dwordx4 v12, s[52:55], s84 offen lds
    s_add_u32 m0, m0, 1024
    v_mfma_f32_32x32x16_bf16 v[224:239], v[24:27], v[92:95], 0
    s_nop 0
    buffer_load_dwordx4 v7, s[52:55], s84 offen lds
    s_add_u32 m0, m0, 1024
    ds_read_b64_tr_b16 v[244:245], v8 offset:2048
    ds_read_b64_tr_b16 v[246:247], v8 offset:3072
    v_mfma_f32_32x32x16_bf16 v[144:159], v[20:23], v[80:83], 0
    v_add_f32 v216, s64, v216
    v_rcp_f32 v216, v216
    s_nop 0
    v_mul_f32 v208, v208, v216
    v_mul_f32 v209, v209, v216
    v_mul_f32 v210, v210, v216
    v_mul_f32 v211, v211, v216
    v_mul_f32 v212, v212, v216
    v_mul_f32 v213, v213, v216
    s_waitcnt lgkmcnt(5)
    v_mfma_f32_32x32x16_bf16 v[160:175], v[240:243], v[80:83], 0
    v_mul_f32 v214, v214, v216
    v_mul_f32 v215, v215, v216
    v_cvt_pk_bf16_f32 v88, v208, v209
    v_cvt_pk_bf16_f32 v89, v210, v211
    v_cvt_pk_bf16_f32 v90, v212, v213
    v_cvt_pk_bf16_f32 v91, v214, v215
    v_add_f32 v232, s64, v232
    v_rcp_f32 v232, v232
    v_mfma_f32_32x32x16_bf16 v[176:191], v[20:23], v[84:87], 0
    v_mul_f32 v224, v224, v232
    v_mul_f32 v225, v225, v232
    v_mul_f32 v226, v226, v232
    v_mul_f32 v227, v227, v232
    v_mul_f32 v228, v228, v232
    v_mul_f32 v229, v229, v232
    v_mul_f32 v230, v230, v232
    v_mul_f32 v231, v231, v232
    v_mfma_f32_32x32x16_bf16 v[192:207], v[240:243], v[84:87], 0
    v_cvt_pk_bf16_f32 v92, v224, v225
    v_cvt_pk_bf16_f32 v93, v226, v227
    v_cvt_pk_bf16_f32 v94, v228, v229
    v_cvt_pk_bf16_f32 v95, v230, v231
    s_waitcnt vmcnt(10)
    v_cvt_pk_bf16_f32 v32, v32, v33
    v_cvt_pk_bf16_f32 v33, v34, v35
    s_waitcnt lgkmcnt(2)
    v_mov_b32 v34, v250
    v_mov_b32 v35, v251
    ds_read_b64_tr_b16 v[36:37], v13 offset:4096
    ds_read_b64_tr_b16 v[38:39], v13 offset:5120
    v_permlane16_swap_b32 v32, v34
    v_permlane16_swap_b32 v33, v35
    ds_read_b64 v[254:255], v253 offset:96
    s_nop 0
    v_mfma_f32_32x32x16_bf16 v[208:223], v[32:35], v[96:99], 0
    buffer_load_dwordx4 v[64:67], v10, s[60:63], s14 offen
    buffer_load_dwordx4 v[120:123], v248, s[60:63], s29 offen
    buffer_load_dwordx4 v[124:127], v249, s[60:63], s29 offen
    buffer_load_dwordx4 v12, s[52:55], s85 offen lds
    s_add_u32 m0, m0, 1024
    v_mfma_f32_32x32x16_bf16 v[224:239], v[32:35], v[100:103], 0
    s_nop 0
    buffer_load_dwordx4 v7, s[52:55], s85 offen lds
    s_add_u32 m0, m0, 1024
    ds_read_b64_tr_b16 v[240:241], v8 offset:4096
    ds_read_b64_tr_b16 v[242:243], v8 offset:5120
    v_mfma_f32_32x32x16_bf16 v[144:159], v[28:31], v[88:91], v[144:159]
    v_add_f32 v216, s64, v216
    v_rcp_f32 v216, v216
    s_nop 0
    v_mul_f32 v208, v208, v216
    v_mul_f32 v209, v209, v216
    v_mul_f32 v210, v210, v216
    v_mul_f32 v211, v211, v216
    v_mul_f32 v212, v212, v216
    v_mul_f32 v213, v213, v216
    s_waitcnt lgkmcnt(5)
    v_mfma_f32_32x32x16_bf16 v[160:175], v[244:247], v[88:91], v[160:175]
    v_mul_f32 v214, v214, v216
    v_mul_f32 v215, v215, v216
    v_cvt_pk_bf16_f32 v96, v208, v209
    v_cvt_pk_bf16_f32 v97, v210, v211
    v_cvt_pk_bf16_f32 v98, v212, v213
    v_cvt_pk_bf16_f32 v99, v214, v215
    v_add_f32 v232, s64, v232
    v_rcp_f32 v232, v232
    v_mfma_f32_32x32x16_bf16 v[176:191], v[28:31], v[92:95], v[176:191]
    v_mul_f32 v224, v224, v232
    v_mul_f32 v225, v225, v232
    v_mul_f32 v226, v226, v232
    v_mul_f32 v227, v227, v232
    v_mul_f32 v228, v228, v232
    v_mul_f32 v229, v229, v232
    v_mul_f32 v230, v230, v232
    v_mul_f32 v231, v231, v232
    v_mfma_f32_32x32x16_bf16 v[192:207], v[244:247], v[92:95], v[192:207]
    v_cvt_pk_bf16_f32 v100, v224, v225
    v_cvt_pk_bf16_f32 v101, v226, v227
    v_cvt_pk_bf16_f32 v102, v228, v229
    v_cvt_pk_bf16_f32 v103, v230, v231
    s_waitcnt vmcnt(10)
    v_cvt_pk_bf16_f32 v40, v40, v41
    v_cvt_pk_bf16_f32 v41, v42, v43
    s_waitcnt lgkmcnt(2)
    v_mov_b32 v42, v254
    v_mov_b32 v43, v255
    ds_read_b64_tr_b16 v[44:45], v13 offset:6144
    ds_read_b64_tr_b16 v[46:47], v13 offset:7168
    v_permlane16_swap_b32 v40, v42
    v_permlane16_swap_b32 v41, v43
    ds_read_b64 v[250:251], v253 offset:128
    s_nop 0
    v_mfma_f32_32x32x16_bf16 v[208:223], v[40:43], v[104:107], 0
    buffer_load_dwordx4 v[72:75], v10, s[60:63], s15 offen
    buffer_load_dwordx4 v[128:131], v248, s[60:63], s30 offen
    buffer_load_dwordx4 v[132:135], v249, s[60:63], s30 offen
    buffer_load_dwordx4 v12, s[52:55], s86 offen lds
    s_add_u32 m0, m0, 1024
    v_mfma_f32_32x32x16_bf16 v[224:239], v[40:43], v[108:111], 0
    s_nop 0
    buffer_load_dwordx4 v7, s[52:55], s86 offen lds
    s_add_u32 m0, m0, 1024
    ds_read_b64_tr_b16 v[244:245], v8 offset:6144
    ds_read_b64_tr_b16 v[246:247], v8 offset:7168
    v_mfma_f32_32x32x16_bf16 v[144:159], v[36:39], v[96:99], v[144:159]
    v_add_f32 v216, s64, v216
    v_rcp_f32 v216, v216
    s_nop 0
    v_mul_f32 v208, v208, v216
    v_mul_f32 v209, v209, v216
    v_mul_f32 v210, v210, v216
    v_mul_f32 v211, v211, v216
    v_mul_f32 v212, v212, v216
    v_mul_f32 v213, v213, v216
    s_waitcnt lgkmcnt(5)
    v_mfma_f32_32x32x16_bf16 v[160:175], v[240:243], v[96:99], v[160:175]
    v_mul_f32 v214, v214, v216
    v_mul_f32 v215, v215, v216
    v_cvt_pk_bf16_f32 v104, v208, v209
    v_cvt_pk_bf16_f32 v105, v210, v211
    v_cvt_pk_bf16_f32 v106, v212, v213
    v_cvt_pk_bf16_f32 v107, v214, v215
    v_add_f32 v232, s64, v232
    v_rcp_f32 v232, v232
    v_mfma_f32_32x32x16_bf16 v[176:191], v[36:39], v[100:103], v[176:191]
    v_mul_f32 v224, v224, v232
    v_mul_f32 v225, v225, v232
    v_mul_f32 v226, v226, v232
    v_mul_f32 v227, v227, v232
    v_mul_f32 v228, v228, v232
    v_mul_f32 v229, v229, v232
    v_mul_f32 v230, v230, v232
    v_mul_f32 v231, v231, v232
    v_mfma_f32_32x32x16_bf16 v[192:207], v[240:243], v[100:103], v[192:207]
    v_cvt_pk_bf16_f32 v108, v224, v225
    v_cvt_pk_bf16_f32 v109, v226, v227
    v_cvt_pk_bf16_f32 v110, v228, v229
    v_cvt_pk_bf16_f32 v111, v230, v231
    s_waitcnt vmcnt(10)
    v_cvt_pk_bf16_f32 v48, v48, v49
    v_cvt_pk_bf16_f32 v49, v50, v51
    s_waitcnt lgkmcnt(2)
    v_mov_b32 v50, v250
    v_mov_b32 v51, v251
    ds_read_b64_tr_b16 v[52:53], v13 offset:8192
    ds_read_b64_tr_b16 v[54:55], v13 offset:9216
    v_permlane16_swap_b32 v48, v50
    v_permlane16_swap_b32 v49, v51
    ds_read_b64 v[254:255], v253 offset:160
    s_nop 0
    v_mfma_f32_32x32x16_bf16 v[208:223], v[48:51], v[112:115], 0
    buffer_load_dwordx4 v[136:139], v248, s[60:63], s31 offen
    buffer_load_dwordx4 v[140:143], v249, s[60:63], s31 offen
    buffer_load_dwordx4 v12, s[52:55], s87 offen lds
    s_add_u32 m0, m0, 1024
    v_mfma_f32_32x32x16_bf16 v[224:239], v[48:51], v[116:119], 0
    s_nop 0
    buffer_load_dwordx4 v7, s[52:55], s87 offen lds
    s_add_u32 m0, m0, 1024
    ds_read_b64_tr_b16 v[240:241], v8 offset:8192
    ds_read_b64_tr_b16 v[242:243], v8 offset:9216
    v_mfma_f32_32x32x16_bf16 v[144:159], v[44:47], v[104:107], v[144:159]
    s_nop 0
    v_add_f32 v216, s64, v216
    v_rcp_f32 v216, v216
    s_nop 0
    v_mul_f32 v208, v208, v216
    v_mul_f32 v209, v209, v216
    v_mul_f32 v210, v210, v216
    v_mul_f32 v211, v211, v216
    v_mul_f32 v212, v212, v216
    v_mul_f32 v213, v213, v216
    s_waitcnt lgkmcnt(5)
    v_mfma_f32_32x32x16_bf16 v[160:175], v[244:247], v[104:107], v[160:175]
    v_mul_f32 v214, v214, v216
    v_mul_f32 v215, v215, v216
    v_cvt_pk_bf16_f32 v112, v208, v209
    v_cvt_pk_bf16_f32 v113, v210, v211
    v_cvt_pk_bf16_f32 v114, v212, v213
    v_cvt_pk_bf16_f32 v115, v214, v215
    v_add_f32 v232, s64, v232
    v_rcp_f32 v232, v232
    v_mfma_f32_32x32x16_bf16 v[176:191], v[44:47], v[108:111], v[176:191]
    v_mul_f32 v224, v224, v232
    v_mul_f32 v225, v225, v232
    v_mul_f32 v226, v226, v232
    v_mul_f32 v227, v227, v232
    v_mul_f32 v228, v228, v232
    v_mul_f32 v229, v229, v232
    v_mul_f32 v230, v230, v232
    v_mul_f32 v231, v231, v232
    v_mfma_f32_32x32x16_bf16 v[192:207], v[244:247], v[108:111], v[192:207]
    v_cvt_pk_bf16_f32 v116, v224, v225
    v_cvt_pk_bf16_f32 v117, v226, v227
    v_cvt_pk_bf16_f32 v118, v228, v229
    v_cvt_pk_bf16_f32 v119, v230, v231
    s_waitcnt vmcnt(9)
    v_cvt_pk_bf16_f32 v56, v56, v57
    v_cvt_pk_bf16_f32 v57, v58, v59
    s_waitcnt lgkmcnt(2)
    v_mov_b32 v58, v254
    v_mov_b32 v59, v255
    ds_read_b64_tr_b16 v[60:61], v13 offset:10240
    ds_read_b64_tr_b16 v[62:63], v13 offset:11264
    v_permlane16_swap_b32 v56, v58
    v_permlane16_swap_b32 v57, v59
    ds_read_b64 v[250:251], v253 offset:192
    s_nop 0
    v_mfma_f32_32x32x16_bf16 v[208:223], v[56:59], v[120:123], 0
    s_lshl_b32 s47, s5, 11
    s_add_u32 m0, s47, 65536
    s_add_u32 s6, s66, 0x10000
    buffer_load_dwordx4 v14, s[56:59], s66 offen lds
    v_mfma_f32_32x32x16_bf16 v[224:239], v[56:59], v[124:127], 0
    s_add_u32 m0, m0, 1024
    global_load_dword v9, v9, s[42:43]
    buffer_load_dwordx4 v14, s[56:59], s6 offen lds
    ds_read_b64_tr_b16 v[244:245], v8 offset:10240
    ds_read_b64_tr_b16 v[246:247], v8 offset:11264
    v_mfma_f32_32x32x16_bf16 v[144:159], v[52:55], v[112:115], v[144:159]
    s_nop 0
    v_add_f32 v216, s64, v216
    v_rcp_f32 v216, v216
    s_nop 0
    v_mul_f32 v208, v208, v216
    v_mul_f32 v209, v209, v216
    v_mul_f32 v210, v210, v216
    v_mul_f32 v211, v211, v216
    v_mul_f32 v212, v212, v216
    v_mul_f32 v213, v213, v216
    s_waitcnt lgkmcnt(5)
    v_mfma_f32_32x32x16_bf16 v[160:175], v[240:243], v[112:115], v[160:175]
    v_mul_f32 v214, v214, v216
    v_mul_f32 v215, v215, v216
    v_cvt_pk_bf16_f32 v120, v208, v209
    v_cvt_pk_bf16_f32 v121, v210, v211
    v_cvt_pk_bf16_f32 v122, v212, v213
    v_cvt_pk_bf16_f32 v123, v214, v215
    v_add_f32 v232, s64, v232
    v_rcp_f32 v232, v232
    v_mfma_f32_32x32x16_bf16 v[176:191], v[52:55], v[116:119], v[176:191]
    v_mul_f32 v224, v224, v232
    v_mul_f32 v225, v225, v232
    v_mul_f32 v226, v226, v232
    v_mul_f32 v227, v227, v232
    v_mul_f32 v228, v228, v232
    v_mul_f32 v229, v229, v232
    v_mul_f32 v230, v230, v232
    v_mul_f32 v231, v231, v232
    v_mfma_f32_32x32x16_bf16 v[192:207], v[240:243], v[116:119], v[192:207]
    v_cvt_pk_bf16_f32 v124, v224, v225
    v_cvt_pk_bf16_f32 v125, v226, v227
    v_cvt_pk_bf16_f32 v126, v228, v229
    v_cvt_pk_bf16_f32 v127, v230, v231
    s_waitcnt vmcnt(7)
    v_cvt_pk_bf16_f32 v64, v64, v65
    v_cvt_pk_bf16_f32 v65, v66, v67
    s_waitcnt lgkmcnt(2)
    v_mov_b32 v66, v250
    v_mov_b32 v67, v251
    ds_read_b64_tr_b16 v[68:69], v13 offset:12288
    ds_read_b64_tr_b16 v[70:71], v13 offset:13312
    v_permlane16_swap_b32 v64, v66
    v_permlane16_swap_b32 v65, v67
    ds_read_b64 v[254:255], v253 offset:224
    s_nop 0
    v_mfma_f32_32x32x16_bf16 v[208:223], v[64:67], v[128:131], 0
    v_mfma_f32_32x32x16_bf16 v[224:239], v[64:67], v[132:135], 0
    ds_read_b64_tr_b16 v[240:241], v8 offset:12288
    ds_read_b64_tr_b16 v[242:243], v8 offset:13312
    v_mfma_f32_32x32x16_bf16 v[144:159], v[60:63], v[120:123], v[144:159]
    s_nop 7
    v_add_f32 v216, s64, v216
    v_rcp_f32 v216, v216
    s_nop 0
    v_mul_f32 v208, v208, v216
    v_mul_f32 v209, v209, v216
    v_mul_f32 v210, v210, v216
    v_mul_f32 v211, v211, v216
    v_mul_f32 v212, v212, v216
    v_mul_f32 v213, v213, v216
    s_waitcnt lgkmcnt(5)
    v_mfma_f32_32x32x16_bf16 v[160:175], v[244:247], v[120:123], v[160:175]
    v_mul_f32 v214, v214, v216
    v_mul_f32 v215, v215, v216
    v_cvt_pk_bf16_f32 v128, v208, v209
    v_cvt_pk_bf16_f32 v129, v210, v211
    v_cvt_pk_bf16_f32 v130, v212, v213
    v_cvt_pk_bf16_f32 v131, v214, v215
    v_add_f32 v232, s64, v232
    v_rcp_f32 v232, v232
    v_mfma_f32_32x32x16_bf16 v[176:191], v[60:63], v[124:127], v[176:191]
    v_mul_f32 v224, v224, v232
    v_mul_f32 v225, v225, v232
    v_mul_f32 v226, v226, v232
    v_mul_f32 v227, v227, v232
    v_mul_f32 v228, v228, v232
    v_mul_f32 v229, v229, v232
    v_mul_f32 v230, v230, v232
    v_mul_f32 v231, v231, v232
    v_mfma_f32_32x32x16_bf16 v[192:207], v[244:247], v[124:127], v[192:207]
    v_cvt_pk_bf16_f32 v132, v224, v225
    v_cvt_pk_bf16_f32 v133, v226, v227
    v_cvt_pk_bf16_f32 v134, v228, v229
    v_cvt_pk_bf16_f32 v135, v230, v231
    s_waitcnt vmcnt(3)
    v_cvt_pk_bf16_f32 v72, v72, v73
    v_cvt_pk_bf16_f32 v73, v74, v75
    s_waitcnt lgkmcnt(2)
    v_mov_b32 v74, v254
    v_mov_b32 v75, v255
    ds_read_b64_tr_b16 v[76:77], v13 offset:14336
    ds_read_b64_tr_b16 v[78:79], v13 offset:15360
    v_permlane16_swap_b32 v72, v74
    v_permlane16_swap_b32 v73, v75
    s_nop 1
    v_mfma_f32_32x32x16_bf16 v[208:223], v[72:75], v[136:139], 0
    v_mfma_f32_32x32x16_bf16 v[224:239], v[72:75], v[140:143], 0
    ds_read_b64_tr_b16 v[244:245], v8 offset:14336
    ds_read_b64_tr_b16 v[246:247], v8 offset:15360
    v_mfma_f32_32x32x16_bf16 v[144:159], v[68:71], v[128:131], v[144:159]
    s_nop 7
    v_add_f32 v216, s64, v216
    v_rcp_f32 v216, v216
    s_nop 0
    v_mul_f32 v208, v208, v216
    v_mul_f32 v209, v209, v216
    v_mul_f32 v210, v210, v216
    v_mul_f32 v211, v211, v216
    v_mul_f32 v212, v212, v216
    v_mul_f32 v213, v213, v216
    s_waitcnt lgkmcnt(4)
    v_mfma_f32_32x32x16_bf16 v[160:175], v[240:243], v[128:131], v[160:175]
    v_mul_f32 v214, v214, v216
    v_mul_f32 v215, v215, v216
    v_cvt_pk_bf16_f32 v136, v208, v209
    v_cvt_pk_bf16_f32 v137, v210, v211
    v_cvt_pk_bf16_f32 v138, v212, v213
    v_cvt_pk_bf16_f32 v139, v214, v215
    v_add_f32 v232, s64, v232
    v_rcp_f32 v232, v232
    v_mfma_f32_32x32x16_bf16 v[176:191], v[68:71], v[132:135], v[176:191]
    v_mul_f32 v224, v224, v232
    v_mul_f32 v225, v225, v232
    v_mul_f32 v226, v226, v232
    v_mul_f32 v227, v227, v232
    v_mul_f32 v228, v228, v232
    v_mul_f32 v229, v229, v232
    v_mul_f32 v230, v230, v232
    v_mul_f32 v231, v231, v232
    v_mfma_f32_32x32x16_bf16 v[192:207], v[240:243], v[132:135], v[192:207]
    v_cvt_pk_bf16_f32 v140, v224, v225
    v_cvt_pk_bf16_f32 v141, v226, v227
    v_cvt_pk_bf16_f32 v142, v228, v229
    v_cvt_pk_bf16_f32 v143, v230, v231
    s_waitcnt lgkmcnt(0)
    s_waitcnt vmcnt(0)
    ds_read_b64_tr_b16 v[16:17], v2 offset:0
    ds_read_b64_tr_b16 v[18:19], v2 offset:256
    ds_read_b64_tr_b16 v[20:21], v2 offset:512
    ds_read_b64_tr_b16 v[22:23], v2 offset:768
    v_mfma_f32_32x32x16_bf16 v[160:175], v[244:247], v[136:139], v[160:175]
    v_sub_f32 v7, 1.0, v9
    v_cvt_pk_bf16_f32 v7, v7, v7
    v_lshlrev_b32 v8, 16, v7
    v_mfma_f32_32x32x16_bf16 v[176:191], v[76:79], v[140:143], v[176:191]
    s_waitcnt lgkmcnt(0)
    v_lshlrev_b32 v32, 16, v16
    v_and_b32 v33, 0xffff0000, v16
    v_lshlrev_b32 v34, 16, v17
    v_and_b32 v35, 0xffff0000, v17
    v_lshlrev_b32 v36, 16, v18
    v_mfma_f32_32x32x16_bf16 v[192:207], v[244:247], v[140:143], v[192:207]
    v_and_b32 v37, 0xffff0000, v18
    v_lshlrev_b32 v38, 16, v19
    v_and_b32 v39, 0xffff0000, v19
    v_lshlrev_b32 v40, 16, v20
    v_and_b32 v41, 0xffff0000, v20
    v_mfma_f32_32x32x16_bf16 v[144:159], v[76:79], v[136:139], v[144:159]
    ds_write_b128 v3, v[160:163] offset:0
    v_lshlrev_b32 v42, 16, v21
    ds_write_b128 v3, v[164:167] offset:1024
    v_and_b32 v43, 0xffff0000, v21
    ds_write_b128 v3, v[168:171] offset:2048
    v_lshlrev_b32 v44, 16, v22
    ds_write_b128 v3, v[172:175] offset:3072
    v_and_b32 v45, 0xffff0000, v22
    ds_write_b128 v4, v[176:179] offset:4096
    v_lshlrev_b32 v46, 16, v23
    ds_write_b128 v4, v[180:183] offset:5120
    v_and_b32 v47, 0xffff0000, v23
    ds_write_b128 v4, v[184:187] offset:6144
    v_pk_mul_f32 v[32:33], v[32:33], v[8:9] op_sel_hi:[1,0]
    ds_write_b128 v4, v[188:191] offset:7168
    v_pk_mul_f32 v[34:35], v[34:35], v[8:9] op_sel_hi:[1,0]
    ds_write_b128 v5, v[192:195] offset:8192
    v_pk_mul_f32 v[36:37], v[36:37], v[8:9] op_sel_hi:[1,0]
    ds_write_b128 v5, v[196:199] offset:9216
    v_pk_mul_f32 v[38:39], v[38:39], v[8:9] op_sel_hi:[1,0]
    ds_write_b128 v5, v[200:203] offset:10240
    v_pk_mul_f32 v[40:41], v[40:41], v[8:9] op_sel_hi:[1,0]
    ds_write_b128 v5, v[204:207] offset:11264
    v_pk_mul_f32 v[42:43], v[42:43], v[8:9] op_sel_hi:[1,0]
    v_pk_mul_f32 v[44:45], v[44:45], v[8:9] op_sel_hi:[1,0]
    v_pk_mul_f32 v[46:47], v[46:47], v[8:9] op_sel_hi:[1,0]
    s_waitcnt lgkmcnt(0)
    s_barrier
    ds_read_b128 v[80:83], v6 offset:0
    ds_read_b128 v[96:99], v6 offset:4096
    ds_read_b128 v[112:115], v6 offset:8192
    ds_read_b128 v[84:87], v6 offset:1024
    ds_read_b128 v[100:103], v6 offset:5120
    ds_read_b128 v[116:119], v6 offset:9216
    ds_read_b128 v[88:91], v6 offset:2048
    ds_read_b128 v[104:107], v6 offset:6144
    ds_read_b128 v[120:123], v6 offset:10240
    ds_read_b128 v[92:95], v6 offset:3072
    ds_read_b128 v[108:111], v6 offset:7168
    ds_read_b128 v[124:127], v6 offset:11264
    s_waitcnt lgkmcnt(9)
    v_pk_add_f32 v[144:145], v[144:145], v[80:81]
    v_pk_add_f32 v[96:97], v[96:97], v[112:113]
    v_pk_add_f32 v[146:147], v[146:147], v[82:83]
    v_pk_add_f32 v[98:99], v[98:99], v[114:115]
    v_pk_add_f32 v[144:145], v[144:145], v[96:97]
    v_pk_add_f32 v[146:147], v[146:147], v[98:99]
    v_pk_fma_f32 v[144:145], v[144:145], v[8:9], v[32:33] op_sel:[0,1,0] op_sel_hi:[1,1,1]
    v_pk_fma_f32 v[146:147], v[146:147], v[8:9], v[34:35] op_sel:[0,1,0] op_sel_hi:[1,1,1]
    v_cvt_pk_bf16_f32 v16, v144, v145
    v_cvt_pk_bf16_f32 v17, v146, v147
    s_waitcnt lgkmcnt(6)
    v_pk_add_f32 v[148:149], v[148:149], v[84:85]
    v_pk_add_f32 v[100:101], v[100:101], v[116:117]
    v_pk_add_f32 v[150:151], v[150:151], v[86:87]
    v_pk_add_f32 v[102:103], v[102:103], v[118:119]
    v_pk_add_f32 v[148:149], v[148:149], v[100:101]
    v_pk_add_f32 v[150:151], v[150:151], v[102:103]
    v_pk_fma_f32 v[148:149], v[148:149], v[8:9], v[36:37] op_sel:[0,1,0] op_sel_hi:[1,1,1]
    v_pk_fma_f32 v[150:151], v[150:151], v[8:9], v[38:39] op_sel:[0,1,0] op_sel_hi:[1,1,1]
    v_cvt_pk_bf16_f32 v18, v148, v149
    v_cvt_pk_bf16_f32 v19, v150, v151
    global_store_dwordx4 v15, v[16:19], s[38:39]
    s_waitcnt lgkmcnt(3)
    v_pk_add_f32 v[152:153], v[152:153], v[88:89]
    v_pk_add_f32 v[104:105], v[104:105], v[120:121]
    v_pk_add_f32 v[154:155], v[154:155], v[90:91]
    v_pk_add_f32 v[106:107], v[106:107], v[122:123]
    v_pk_add_f32 v[152:153], v[152:153], v[104:105]
    v_pk_add_f32 v[154:155], v[154:155], v[106:107]
    v_pk_fma_f32 v[152:153], v[152:153], v[8:9], v[40:41] op_sel:[0,1,0] op_sel_hi:[1,1,1]
    v_pk_fma_f32 v[154:155], v[154:155], v[8:9], v[42:43] op_sel:[0,1,0] op_sel_hi:[1,1,1]
    v_cvt_pk_bf16_f32 v20, v152, v153
    v_cvt_pk_bf16_f32 v21, v154, v155
    s_waitcnt lgkmcnt(0)
    v_pk_add_f32 v[156:157], v[156:157], v[92:93]
    v_pk_add_f32 v[108:109], v[108:109], v[124:125]
    v_pk_add_f32 v[158:159], v[158:159], v[94:95]
    v_pk_add_f32 v[110:111], v[110:111], v[126:127]
    v_pk_add_f32 v[156:157], v[156:157], v[108:109]
    v_pk_add_f32 v[158:159], v[158:159], v[110:111]
    v_pk_fma_f32 v[156:157], v[156:157], v[8:9], v[44:45] op_sel:[0,1,0] op_sel_hi:[1,1,1]
    v_pk_fma_f32 v[158:159], v[158:159], v[8:9], v[46:47] op_sel:[0,1,0] op_sel_hi:[1,1,1]
    v_cvt_pk_bf16_f32 v22, v156, v157
    v_cvt_pk_bf16_f32 v23, v158, v159
    global_store_dwordx4 v15, v[20:23], s[38:39] offset:16
    s_nop 1
K2_exit:
    s_endpgm
.p2align 10
CODE_END:
.section .rodata,"a"
.p2align 6
.amdhsa_kernel k1_kernel
  .amdhsa_next_free_vgpr 256
  .amdhsa_next_free_sgpr 100
  .amdhsa_accum_offset 256
  .amdhsa_group_segment_fixed_size 0
  .amdhsa_kernarg_size 112
  .amdhsa_user_sgpr_count 2
  .amdhsa_user_sgpr_kernarg_segment_ptr 1
  .amdhsa_system_sgpr_workgroup_id_x 1
.end_amdhsa_kernel
.p2align 6
.amdhsa_kernel k2_kernel
  .amdhsa_next_free_vgpr 256
  .amdhsa_next_free_sgpr 100
  .amdhsa_accum_offset 256
  .amdhsa_group_segment_fixed_size 0
  .amdhsa_kernarg_size 112
  .amdhsa_user_sgpr_count 2
  .amdhsa_user_sgpr_kernarg_segment_ptr 1
  .amdhsa_system_sgpr_workgroup_id_x 1
.end_amdhsa_kernel
```
